```python
import torch

def _softmax(x, axis=-1):
    return torch.softmax(x, dim=axis)
def _gelu(x):
    return torch.nn.functional.gelu(x, approximate="tanh")
def _silu(x):
    return torch.nn.functional.silu(x)
def _sigmoid(x):
    return torch.sigmoid(x)
def _layernorm(x, axis=-1, eps=1e-5):
    m = x.mean(dim=axis, keepdim=True)
    v = x.var(dim=axis, keepdim=True, unbiased=False)
    return (x - m) / torch.sqrt(v + eps)
def _scatter_add(tgt, idx, src, axis=0):
    return tgt.clone().index_add_(axis, idx, src)
def _segment_sum(src, seg, n):
    out = torch.zeros((n,) + src.shape[1:], dtype=src.dtype)
    return out.index_add_(0, seg, src)
def _pad(x, pw):
    flat = tuple(v for pair in reversed(pw) for v in pair)
    return torch.nn.functional.pad(x, flat)

kernel_name = 'recurrent_scan__linear_attn_block__dense_activation_squared_relu__prompt'

def setup_inputs():

    _w = (lambda a: (lambda t: t.to(torch.bfloat16) if t.is_floating_point() else t)(torch.as_tensor(a)))
    def _A_setup():
        B, S, D = 1, 2048, 448
        return {
            "x": _w((lambda *s: torch.randn(*s, dtype=torch.bfloat16) * 0.05)(B, S, D)),
            "wqkv": _w((lambda *s: torch.randn(*s, dtype=torch.bfloat16) * 0.1)(D, 3 * D)),
            "wo": _w((lambda *s: torch.randn(*s, dtype=torch.bfloat16) * 0.05)(D, D)),
        }
    _A_in = _A_setup()

    def _B_setup():
        B, S, D, F = 1, 2048, 448, 1792
        return {
            "x": _w((lambda *s: torch.randn(*s, dtype=torch.bfloat16) * 0.05)(B, S, D)),
            "w1": _w((lambda *s: torch.randn(*s, dtype=torch.bfloat16) * 0.05)(D, F)),
            "b1": _w((lambda *s: torch.randn(*s, dtype=torch.bfloat16) * 0.2)(F)),
            "w2": _w((lambda *s: torch.randn(*s, dtype=torch.bfloat16) * 0.05)(F, D)),
            "b2": _w((lambda *s: torch.randn(*s, dtype=torch.bfloat16) * 0.8)(D)),
        }
    _B_in = _B_setup()

    return {
        "A_x": _A_in["x"],
        "A_wqkv": _A_in["wqkv"],
        "A_wo": _A_in["wo"],
        "B_x": _B_in["x"],
        "B_w1": _B_in["w1"],
        "B_b1": _B_in["b1"],
        "B_w2": _B_in["w2"],
        "B_b2": _B_in["b2"],
    }

def reference(A_x, A_wqkv, A_wo, B_x, B_w1, B_b1, B_w2, B_b2):
    def _A_ref(x, wqkv, wo):
        B, S, D = x.shape
        H = 16; Dh = D // H
        qkv = (lambda x, *d: x.permute(*d))((x @ wqkv).reshape(B, S, 3, H, Dh), 2, 0, 3, 1, 4)
        q, k, v = qkv[0], qkv[1], qkv[2]
        phi = lambda t: torch.where(t > 0, t + 1, torch.exp(t)) + 1e-6
        pq, pk = phi(q), phi(k)
        kv = torch.einsum("bhsd,bhse->bhde", pk, v)
        z = torch.einsum("bhsd->bhd", pk)
        num = torch.einsum("bhqd,bhde->bhqe", pq, kv)
        den = torch.einsum("bhqd,bhd->bhq", pq, z)[..., None] + 1e-6
        o = num / den
        return (lambda x, *d: x.permute(*d))(o, 0, 2, 1, 3).reshape(B, S, D) @ wo

    def _B_ref(x, w1, b1, w2, b2):
        h = torch.einsum("bsd,df->bsf", x, w1) + b1
        zero = torch.zeros_like(h)
        r = torch.where(h > zero, h, zero)
        h = r * r
        out = torch.einsum("bsf,fd->bsd", h, w2) + b2
        return out

    x = A_x
    xn = _layernorm(x, axis=-1)
    s = _A_ref(xn, A_wqkv, A_wo)
    g = _silu(_B_ref(xn, B_w1, B_b1, B_w2, B_b2))
    return x + s * g
```

```asm
; @launch grid=(256,1,1) block=(256,1,1) lds=163840
.amdgcn_target "amdgcn-amd-amdhsa--gfx950"
.text
.globl recurrent_scan__linear_attn_block__dense_activation_squared_relu__prompt_kernel
.p2align 8
.type recurrent_scan__linear_attn_block__dense_activation_squared_relu__prompt_kernel,@function
recurrent_scan__linear_attn_block__dense_activation_squared_relu__prompt_kernel:
  s_cmp_ge_u32 s2, 256
  s_cbranch_scc1 L_END
  s_load_dwordx2 s[4:5], s[0:1], 0
  s_load_dwordx2 s[36:37], s[0:1], 8
  s_load_dwordx2 s[12:13], s[0:1], 80
  s_load_dwordx2 s[20:21], s[0:1], 48
  s_load_dwordx2 s[40:41], s[0:1], 16
  s_load_dwordx2 s[38:39], s[0:1], 32
  s_load_dwordx2 s[16:17], s[0:1], 40
  s_load_dwordx2 s[28:29], s[0:1], 56
  s_load_dwordx2 s[24:25], s[0:1], 64
  s_load_dwordx2 s[32:33], s[0:1], 72
  v_and_b32 v1, 63, v0
  v_lshrrev_b32 v108, 6, v0
  v_lshrrev_b32 v109, 3, v1
  v_readfirstlane_b32 s64, v108
  v_and_b32 v110, 7, v1
  v_lshrrev_b32 v111, 4, v1
  v_xor_b32 v112, v110, v111
  v_lshlrev_b32 v112, 4, v112
  v_mov_b32 v113, 896
  v_mad_u32_u24 v96, v109, v113, v112
  v_xor_b32 v97, 64, v96
  v_add_u32 v98, 12288, v96
  v_add_u32 v99, 18432, v97
  v_add_u32 v97, 6144, v97
  s_and_b32 s75, s2, 7
  s_lshr_b32 s76, s2, 3
  s_and_b32 s77, s76, 3
  s_lshr_b32 s69, s76, 2
  s_lshl_b32 s68, s75, 2
  s_add_u32 s68, s68, s77
  s_lshr_b32 s66, s75, 1
  s_lshl_b32 s66, s66, 2
  s_add_u32 s66, s66, s77
  s_and_b32 s67, s75, 1
  s_lshl_b32 s67, s67, 3
  s_add_u32 s67, s67, s69
  s_lshl_b32 s76, s77, 1
  s_add_u32 s76, s76, s69
  s_sub_u32 s57, s76, 7
  s_cselect_b32 s57, s76, s57
  s_mul_i32 s65, s64, 40960
  s_lshl_b32 s86, s66, 2
  s_add_u32 s86, s86, s64
  s_mul_i32 s74, s86, 28672
  s_mov_b32 s6, 1835008
  s_mov_b32 s7, 0x00020000
  s_mov_b32 s14, 10485760
  s_mov_b32 s15, 0x00020000
  s_add_u32 s58, s57, 1
  s_cmp_eq_u32 s58, 7
  s_cselect_b32 s58, 0, s58
  s_add_u32 s59, s58, 1
  s_cmp_eq_u32 s59, 7
  s_cselect_b32 s59, 0, s59
  s_add_u32 s60, s59, 1
  s_cmp_eq_u32 s60, 7
  s_cselect_b32 s60, 0, s60
  s_add_u32 s61, s60, 1
  s_cmp_eq_u32 s61, 7
  s_cselect_b32 s61, 0, s61
  s_add_u32 s62, s61, 1
  s_cmp_eq_u32 s62, 7
  s_cselect_b32 s62, 0, s62
  s_add_u32 s63, s62, 1
  s_cmp_eq_u32 s63, 7
  s_cselect_b32 s63, 0, s63
  v_lshl_add_u32 v20, s64, 3, v109
  v_lshrrev_b32 v112, 2, v110
  v_and_b32 v113, 1, v111
  v_xor_b32 v112, v112, v113
  v_and_b32 v113, 3, v110
  v_lshlrev_b32 v113, 4, v113
  v_lshl_add_u32 v21, v112, 6, v113
  s_movk_i32 s75, 2688
  s_movk_i32 s100, 896
  v_mad_u32_u24 v10, v20, s75, v113
  v_mad_u32_u24 v10, v112, s100, v10
  s_mov_b32 s10, 1204224
  s_mov_b32 s11, 0x00020000
  s_mul_i32 s75, s67, 56
  s_and_b32 s101, s67, 1
  s_lshl_b32 s101, s101, 3
  s_sub_u32 s75, s75, s101
  s_add_u32 s75, s75, 896
  v_add_u32 v10, s75, v10
  v_add_u32 v11, 84992, v10
  s_mul_i32 s50, s57, 172032
  s_mul_i32 s51, s58, 172032
  s_mul_i32 s52, s59, 172032
  s_mul_i32 s53, s60, 172032
  s_mul_i32 s54, s61, 172032
  s_mul_i32 s55, s62, 172032
  s_mul_i32 s56, s63, 172032
  v_mov_b32 v120, v10
  v_mov_b32 v121, v11
  s_mov_b32 s82, 1204224
  s_mov_b32 s83, 0x00020000
  s_waitcnt lgkmcnt(0)
  s_mov_b64 s[8:9], s[36:37]
  s_mov_b64 s[80:81], s[36:37]
  s_cmp_lg_u32 s2, 0
  s_cbranch_scc1 L_NZ
  v_lshrrev_b32 v112, 2, v1
  v_and_b32 v113, 3, v1
  v_lshlrev_b32 v112, 7, v112
  v_lshl_add_u32 v112, v113, 4, v112
  v_mov_b32 v116, 0
  v_mov_b32 v117, 0
  v_mov_b32 v118, 0
  v_mov_b32 v119, 0
  s_mul_i32 s75, s64, 6144
  s_add_u32 s75, s75, 10289152
  buffer_store_dwordx4 v[116:119], v112, s[12:15], s75 offen sc1
  buffer_store_dwordx4 v[116:119], v112, s[12:15], s75 offen offset:2048 sc1
  s_add_u32 s75, s75, 4096
  buffer_store_dwordx4 v[116:119], v112, s[12:15], s75 offen sc1
L_NZ:
  s_lshl_b32 s75, s57, 7
  s_add_u32 m0, s65, 12288
  s_add_u32 s75, s75, s74
  buffer_load_dwordx4 v96, s[4:7], s75 offen offset:0 lds
  buffer_load_dwordx4 v97, s[4:7], s75 offen offset:1024 lds
  buffer_load_dwordx4 v98, s[4:7], s75 offen offset:2048 lds
  buffer_load_dwordx4 v99, s[4:7], s75 offen offset:3072 lds
  s_add_u32 m0, s65, 0
  s_nop 0
  buffer_load_dwordx4 v120, s[80:83], s50 offen lds
  s_add_u32 m0, s65, 2048
  s_nop 0
  buffer_load_dwordx4 v121, s[80:83], s50 offen offset:1024 lds
  s_lshl_b32 s75, s58, 7
  s_add_u32 m0, s65, 16384
  s_add_u32 s75, s75, s74
  buffer_load_dwordx4 v96, s[4:7], s75 offen offset:0 lds
  buffer_load_dwordx4 v97, s[4:7], s75 offen offset:1024 lds
  buffer_load_dwordx4 v98, s[4:7], s75 offen offset:2048 lds
  buffer_load_dwordx4 v99, s[4:7], s75 offen offset:3072 lds
  s_add_u32 m0, s65, 2048
  s_nop 0
  buffer_load_dwordx4 v120, s[80:83], s51 offen lds
  s_add_u32 m0, s65, 4096
  s_nop 0
  buffer_load_dwordx4 v121, s[80:83], s51 offen offset:1024 lds
  s_lshl_b32 s76, s76, 13
  s_add_u32 s88, s76, 0
  s_and_b32 s88, s88, 0xffff
  s_add_u32 s89, s76, 8192
  s_and_b32 s89, s89, 0xffff
  s_add_u32 s90, s76, 16384
  s_and_b32 s90, s90, 0xffff
  s_add_u32 s91, s76, 24576
  s_and_b32 s91, s91, 0xffff
  s_add_u32 s92, s76, 32768
  s_and_b32 s92, s92, 0xffff
  s_add_u32 s93, s76, 40960
  s_and_b32 s93, s93, 0xffff
  s_add_u32 s94, s76, 49152
  s_and_b32 s94, s94, 0xffff
  s_add_u32 s95, s76, 57344
  s_and_b32 s95, s95, 0xffff
  s_add_u32 s76, s77, s69
  s_mul_i32 s75, s76, 11
  s_lshr_b32 s75, s75, 5
  s_mul_i32 s75, s75, 3
  s_sub_u32 s76, s76, s75
  s_lshl_b32 s76, s76, 13
  s_add_u32 s96, s76, 0x10000
  s_mov_b32 s99, 90112
  s_add_u32 s97, s96, 8192
  s_cmp_eq_u32 s97, s99
  s_cselect_b32 s97, 0x10000, s97
  s_add_u32 s98, s97, 8192
  s_cmp_eq_u32 s98, s99
  s_cselect_b32 s98, 0x10000, s98
  s_mov_b32 s22, 1605632
  s_mov_b32 s23, 0x00020000
  s_mov_b32 s19, 0x00020000
  s_mov_b32 s26, 1835008
  s_mov_b32 s27, 0x00020000
  s_mov_b32 s30, 896
  s_mov_b32 s31, 0x00020000
  s_mov_b32 s34, 256
  s_mov_b32 s35, 0x00020000
  s_lshl_b32 s0, s86, 7
  s_lshl_b32 s75, s67, 2
  s_add_u32 s0, s0, s75
  s_add_u32 s0, s0, 10289152
  s_add_u32 s1, s75, s64
  s_lshl_b32 s1, s1, 7
  s_lshl_b32 s75, s66, 2
  s_add_u32 s1, s1, s75
  s_add_u32 s1, s1, 10297344
  s_mul_i32 s75, s64, 14336
  s_lshl_b32 s76, s69, 7
  s_add_u32 s75, s75, s76
  v_mad_u32_u24 v23, v109, s100, v21
  v_add_u32 v23, s75, v23
  v_add_u32 v24, 6144, v23
  v_add_u32 v25, 55296, v23
  v_add_u32 v26, 61440, v23
  v_lshrrev_b32 v112, 5, v1
  v_bfe_u32 v113, v1, 2, 2
  v_lshlrev_b32 v114, 7, v113
  v_bfe_u32 v115, v1, 3, 1
  v_lshl_add_u32 v114, v115, 6, v114
  v_bfe_u32 v115, v1, 4, 1
  v_lshl_add_u32 v114, v115, 5, v114
  v_and_b32 v115, 3, v1
  v_lshl_add_u32 v114, v115, 3, v114
  v_mul_u32_u24 v2, 40960, v112
  v_add_u32 v2, v2, v114
  v_xor_b32 v3, 64, v2
  v_add_u32 v4, 81920, v2
  v_add_u32 v5, 81920, v3
  v_lshl_add_u32 v27, v112, 9, v114
  v_add_u32 v27, s65, v27
  v_xor_b32 v28, 64, v27
  v_bfe_u32 v113, v1, 1, 3
  v_xor_b32 v113, v113, v112
  v_lshlrev_b32 v100, 4, v113
  v_lshl_add_u32 v100, v110, 7, v100
  v_bfe_u32 v113, v1, 3, 2
  v_lshl_add_u32 v100, v113, 10, v100
  s_add_u32 s75, s65, 12288
  v_add_u32 v100, s75, v100
  v_xor_b32 v101, 32, v100
  v_xor_b32 v102, 64, v100
  v_xor_b32 v103, 96, v100
  v_lshlrev_b32 v8, 4, v1
  v_and_b32 v113, 31, v1
  v_lshlrev_b32 v22, 1, v113
  v_xor_b32 v114, v110, v112
  v_lshlrev_b32 v114, 4, v114
  v_lshl_add_u32 v140, v113, 8, v114
  v_add_u32 v140, s65, v140
  v_lshlrev_b32 v114, 1, v110
  v_xor_b32 v114, v114, v109
  v_lshlrev_b32 v114, 4, v114
  v_lshl_add_u32 v141, v109, 8, v114
  s_lshl_b32 s75, s64, 12
  v_add_u32 v141, s75, v141
  v_lshlrev_b32 v114, 4, v110
  v_mad_u32_u24 v142, v109, s100, v114
  v_and_b32 v114, 15, v1
  v_lshlrev_b32 v114, 2, v114
  v_bfe_u32 v115, v1, 4, 1
  v_lshl_add_u32 v143, v115, 7, v114
  s_mul_i32 s75, s68, 229376
  s_lshl_b32 s76, s64, 10
  s_add_u32 s75, s75, s76
  v_add_u32 v136, s75, v8
  v_add_u32 v137, 114688, v136
  v_add_u32 v138, 4096, v136
  v_add_u32 v139, 4096, v137
  s_mov_b32 s79, 0x3f803f80
  s_mov_b32 s78, 0x35c1a2a0
  s_cmp_lg_u32 s69, 7
  s_cbranch_scc1 L_NPF
  s_and_b32 s75, s68, 3
  s_lshl_b32 s75, s75, 2
  s_add_u32 s75, s75, s64
  s_lshl_b32 s75, s75, 12
  v_add_u32 v23, s75, v8
  v_add_u32 v24, s75, v8
  v_add_u32 v25, s75, v8
  v_add_u32 v26, s75, v8
  s_mov_b32 s88, 90112
  s_mov_b32 s89, 94800
  s_mov_b32 s90, 99488
  s_mov_b32 s91, 104176
  s_mov_b32 s92, 108864
  s_mov_b32 s93, 0
  s_mov_b32 s94, 4688
  s_mov_b32 s95, 9376
  s_mov_b32 s96, 14064
  s_mov_b32 s97, 18752
L_NPF:
  s_mov_b64 s[42:43], s[38:39]
  s_cmp_lt_u32 s67, 28
  s_cselect_b32 s44, 1605632, 0
  s_cselect_b32 s47, 3584, 0
  s_lshl_b32 s45, s67, 7
  s_mov_b32 s48, s45
  s_movk_i32 s46, 3584
  s_mov_b32 s49, 229376
  v_mov_b32 v12, 0
  v_mov_b32 v13, 0
  v_lshrrev_b32 v112, 2, v1
  v_xor_b32 v112, v112, v111
  v_and_b32 v112, 1, v112
  v_and_b32 v113, 8, v1
  v_or_b32 v112, v112, v113
  v_mov_b32 v113, s79
  v_cmp_eq_u32 vcc, 0, v112
  s_nop 1
  v_cndmask_b32 v114, 0, v113, vcc
  v_cmp_eq_u32 vcc, 8, v112
  s_nop 1
  v_cndmask_b32 v115, 0, v113, vcc
  v_accvgpr_write_b32 a160, v114
  v_accvgpr_write_b32 a161, v114
  v_accvgpr_write_b32 a162, v115
  v_accvgpr_write_b32 a163, v115
  s_lshl_b32 s75, s59, 7
  s_add_u32 m0, s65, 20480
  s_add_u32 s75, s75, s74
  buffer_load_dwordx4 v96, s[4:7], s75 offen offset:0 lds
  buffer_load_dwordx4 v97, s[4:7], s75 offen offset:1024 lds
  buffer_load_dwordx4 v98, s[4:7], s75 offen offset:2048 lds
  buffer_load_dwordx4 v99, s[4:7], s75 offen offset:3072 lds
  s_add_u32 m0, s65, 4096
  s_nop 0
  buffer_load_dwordx4 v120, s[80:83], s52 offen lds
  s_add_u32 m0, s65, 6144
  s_nop 0
  buffer_load_dwordx4 v121, s[80:83], s52 offen offset:1024 lds
  s_waitcnt vmcnt(14)
  s_cmp_lg_u32 s2, 0
  s_cbranch_scc1 L_NC
  v_mov_b32 v116, 1
  s_lshl_b32 s75, s64, 2
  buffer_store_dword v116, off, s[32:35], s75 sc1
L_NC:
  s_waitcnt vmcnt(14)
  ds_read_b128 v[144:147], v100 offset:0
  ds_read_b128 v[148:151], v101 offset:0
  ds_read_b128 v[152:155], v102 offset:0
  ds_read_b128 v[156:159], v103 offset:0
  s_waitcnt vmcnt(12)
  s_barrier
  ds_read_b64_tr_b16 a[224:225], v2 offset:0
  ds_read_b64_tr_b16 a[226:227], v2 offset:512
  ds_read_b64_tr_b16 a[228:229], v3 offset:0
  ds_read_b64_tr_b16 a[230:231], v3 offset:512
  ds_read_b64_tr_b16 a[232:233], v4 offset:0
  ds_read_b64_tr_b16 a[234:235], v4 offset:512
  ds_read_b64_tr_b16 a[236:237], v5 offset:0
  ds_read_b64_tr_b16 a[238:239], v5 offset:512
  ds_read_b64_tr_b16 a[240:241], v2 offset:3072
  ds_read_b64_tr_b16 a[242:243], v2 offset:3584
  ds_read_b64_tr_b16 a[244:245], v3 offset:3072
  ds_read_b64_tr_b16 a[246:247], v3 offset:3584
  s_waitcnt lgkmcnt(8)
  v_mfma_f32_32x32x16_bf16 v[32:47], a[224:227], v[144:147], 0
  ds_read_b64_tr_b16 a[248:249], v4 offset:3072
  ds_read_b64_tr_b16 a[250:251], v4 offset:3584
  s_lshl_b32 s75, s60, 7
  s_add_u32 m0, s65, 24576
  s_add_u32 s75, s75, s74
  buffer_load_dwordx4 v96, s[4:7], s75 offen offset:0 lds
  buffer_load_dwordx4 v97, s[4:7], s75 offen offset:1024 lds
  buffer_load_dwordx4 v98, s[4:7], s75 offen offset:2048 lds
  buffer_load_dwordx4 v99, s[4:7], s75 offen offset:3072 lds
  v_dot2_f32_bf16 v106, v144, v144, 0
  v_dot2_f32_bf16 v107, v145, v145, 0
  ds_read_b64_tr_b16 a[164:165], v27 offset:0
  ds_read_b64_tr_b16 a[166:167], v28 offset:0
  v_mfma_f32_32x32x16_bf16 v[48:63], a[228:231], v[144:147], 0
  ds_read_b64_tr_b16 a[252:253], v5 offset:3072
  s_add_u32 m0, s65, 6144
  ds_read_b64_tr_b16 a[254:255], v5 offset:3584
  buffer_load_dwordx4 v120, s[80:83], s53 offen lds
  s_add_u32 m0, s65, 8192
  s_nop 0
  buffer_load_dwordx4 v121, s[80:83], s53 offen offset:1024 lds
  v_dot2c_f32_bf16 v106, v146, v146
  v_dot2c_f32_bf16 v107, v147, v147
  v_mfma_f32_16x16x32_bf16 v[80:83], a[160:163], v[144:147], 0
  ds_read_b64_tr_b16 a[168:169], v27 offset:3072
  ds_read_b64_tr_b16 a[170:171], v28 offset:3072
  s_waitcnt lgkmcnt(12)
  v_mfma_f32_32x32x16_bf16 v[32:47], a[232:235], v[148:151], v[32:47]
  s_waitcnt vmcnt(12)
  s_barrier
  ds_read_b64_tr_b16 a[224:225], v2 offset:2048
  ds_read_b64_tr_b16 a[226:227], v2 offset:2560
  s_waitcnt vmcnt(14)
  ds_read_b128 v[160:163], v100 offset:4096
  ds_read_b128 v[164:167], v101 offset:4096
  ds_read_b128 v[168:171], v102 offset:4096
  ds_read_b128 v[172:175], v103 offset:4096
  v_dot2c_f32_bf16 v106, v148, v148
  v_dot2c_f32_bf16 v107, v149, v149
  v_mfma_f32_32x32x16_bf16 v[48:63], a[236:239], v[148:151], v[48:63]
  ds_read_b64_tr_b16 a[228:229], v3 offset:2048
  s_add_u32 m0, s65, 0
  ds_read_b64_tr_b16 a[230:231], v3 offset:2560
  buffer_load_dwordx4 v11, s[8:11], s56 offen offset:1024 lds
  s_mov_b64 s[8:9], s[42:43]
  s_mov_b32 s10, s44
  s_mul_i32 s50, s57, s49
  v_mad_u32_u24 v10, v20, s46, v21
  v_add_u32 v10, s45, v10
  v_dot2c_f32_bf16 v106, v150, v150
  v_dot2c_f32_bf16 v107, v151, v151
  v_mfma_f32_16x16x32_bf16 v[80:83], a[160:163], v[148:151], v[80:83]
  s_waitcnt lgkmcnt(12)
  v_mfma_f32_16x16x32_bf16 a[172:175], a[160:163], a[164:167], 0
  s_waitcnt lgkmcnt(15)
  v_mfma_f32_32x32x16_bf16 v[32:47], a[240:243], v[152:155], v[32:47]
  ds_read_b64_tr_b16 a[232:233], v4 offset:2048
  ds_read_b64_tr_b16 a[234:235], v4 offset:2560
  v_dot2c_f32_bf16 v106, v152, v152
  v_dot2c_f32_bf16 v107, v153, v153
  s_waitcnt lgkmcnt(10)
  v_mfma_f32_16x16x32_bf16 a[172:175], a[160:163], a[168:171], a[172:175]
  v_mfma_f32_32x32x16_bf16 v[48:63], a[244:247], v[152:155], v[48:63]
  ds_read_b64_tr_b16 a[236:237], v5 offset:2048
  s_add_u32 m0, s65, 0
  ds_read_b64_tr_b16 a[238:239], v5 offset:2560
  buffer_load_dwordx4 v10, s[8:11], s50 offen lds
  s_lshr_b32 s77, s49, 1
  s_sub_u32 s77, s77, 1024
  v_add_u32 v11, s77, v10
  s_mul_i32 s51, s58, s49
  v_dot2c_f32_bf16 v106, v154, v154
  v_dot2c_f32_bf16 v107, v155, v155
  v_mfma_f32_16x16x32_bf16 v[80:83], a[160:163], v[152:155], v[80:83]
  ds_read_b64_tr_b16 a[164:165], v27 offset:2048
  ds_read_b64_tr_b16 a[166:167], v28 offset:2048
  s_waitcnt lgkmcnt(15)
  v_mfma_f32_32x32x16_bf16 v[32:47], a[248:251], v[156:159], v[32:47]
  ds_read_b64_tr_b16 a[240:241], v2 offset:5120
  ds_read_b64_tr_b16 a[242:243], v2 offset:5632
  v_dot2c_f32_bf16 v106, v156, v156
  v_dot2c_f32_bf16 v107, v157, v157
  ds_read_b64_tr_b16 a[168:169], v27 offset:5120
  ds_read_b64_tr_b16 a[170:171], v28 offset:5120
  v_mfma_f32_32x32x16_bf16 v[48:63], a[252:255], v[156:159], v[48:63]
  ds_read_b64_tr_b16 a[244:245], v3 offset:5120
  ds_read_b64_tr_b16 a[246:247], v3 offset:5632
  s_mov_b32 s18, s47
  buffer_load_ushort v14, v22, s[16:19], s48 offen
  buffer_load_ushort v15, v22, s[16:19], s48 offen offset:64
  v_dot2c_f32_bf16 v106, v158, v158
  v_dot2c_f32_bf16 v107, v159, v159
  v_mfma_f32_16x16x32_bf16 v[80:83], a[160:163], v[156:159], v[80:83]
  s_waitcnt lgkmcnt(12)
  v_mfma_f32_32x32x16_bf16 v[32:47], a[224:227], v[160:163], v[32:47]
  ds_read_b64_tr_b16 a[248:249], v4 offset:5120
  ds_read_b64_tr_b16 a[250:251], v4 offset:5632
  s_lshl_b32 s75, s61, 7
  s_add_u32 m0, s65, 28672
  s_add_u32 s75, s75, s74
  buffer_load_dwordx4 v96, s[4:7], s75 offen offset:0 lds
  buffer_load_dwordx4 v97, s[4:7], s75 offen offset:1024 lds
  buffer_load_dwordx4 v98, s[4:7], s75 offen offset:2048 lds
  buffer_load_dwordx4 v99, s[4:7], s75 offen offset:3072 lds
  v_dot2c_f32_bf16 v106, v160, v160
  v_dot2c_f32_bf16 v107, v161, v161
  s_waitcnt lgkmcnt(8)
  v_mfma_f32_16x16x32_bf16 a[172:175], a[160:163], a[164:167], a[172:175]
  v_mfma_f32_32x32x16_bf16 v[48:63], a[228:231], v[160:163], v[48:63]
  ds_read_b64_tr_b16 a[252:253], v5 offset:5120
  s_add_u32 m0, s65, 8192
  ds_read_b64_tr_b16 a[254:255], v5 offset:5632
  buffer_load_dwordx4 v120, s[80:83], s54 offen lds
  s_add_u32 m0, s65, 10240
  s_nop 0
  buffer_load_dwordx4 v121, s[80:83], s54 offen offset:1024 lds
  v_dot2c_f32_bf16 v106, v162, v162
  v_dot2c_f32_bf16 v107, v163, v163
  v_mfma_f32_16x16x32_bf16 v[80:83], a[160:163], v[160:163], v[80:83]
  s_waitcnt lgkmcnt(6)
  v_mfma_f32_16x16x32_bf16 a[172:175], a[160:163], a[168:171], a[172:175]
  s_waitcnt lgkmcnt(12)
  v_mfma_f32_32x32x16_bf16 v[32:47], a[232:235], v[164:167], v[32:47]
  s_waitcnt vmcnt(16)
  s_barrier
  ds_read_b64_tr_b16 a[224:225], v2 offset:4096
  ds_read_b64_tr_b16 a[226:227], v2 offset:4608
  s_waitcnt vmcnt(18)
  ds_read_b128 v[176:179], v100 offset:8192
  ds_read_b128 v[180:183], v101 offset:8192
  ds_read_b128 v[184:187], v102 offset:8192
  ds_read_b128 v[188:191], v103 offset:8192
  v_dot2c_f32_bf16 v106, v164, v164
  v_dot2c_f32_bf16 v107, v165, v165
  ds_read_b64_tr_b16 a[164:165], v27 offset:4096
  ds_read_b64_tr_b16 a[166:167], v28 offset:4096
  v_mfma_f32_32x32x16_bf16 v[48:63], a[236:239], v[164:167], v[48:63]
  ds_read_b64_tr_b16 a[228:229], v3 offset:4096
  s_add_u32 m0, s65, 2048
  ds_read_b64_tr_b16 a[230:231], v3 offset:4608
  buffer_load_dwordx4 v11, s[8:11], s50 offen offset:1024 lds
  v_dot2c_f32_bf16 v106, v166, v166
  v_dot2c_f32_bf16 v107, v167, v167
  v_mfma_f32_16x16x32_bf16 v[80:83], a[160:163], v[164:167], v[80:83]
  ds_read_b64_tr_b16 a[168:169], v27 offset:7168
  ds_read_b64_tr_b16 a[170:171], v28 offset:7168
  s_waitcnt lgkmcnt(15)
  v_mfma_f32_32x32x16_bf16 v[32:47], a[240:243], v[168:171], v[32:47]
  ds_read_b64_tr_b16 a[232:233], v4 offset:4096
  ds_read_b64_tr_b16 a[234:235], v4 offset:4608
  v_dot2c_f32_bf16 v106, v168, v168
  v_dot2c_f32_bf16 v107, v169, v169
  v_mfma_f32_32x32x16_bf16 v[48:63], a[244:247], v[168:171], v[48:63]
  ds_read_b64_tr_b16 a[236:237], v5 offset:4096
  s_add_u32 m0, s65, 2048
  ds_read_b64_tr_b16 a[238:239], v5 offset:4608
  buffer_load_dwordx4 v10, s[8:11], s51 offen lds
  s_mul_i32 s52, s59, s49
  v_dot2c_f32_bf16 v106, v170, v170
  v_dot2c_f32_bf16 v107, v171, v171
  v_mfma_f32_16x16x32_bf16 v[80:83], a[160:163], v[168:171], v[80:83]
  s_waitcnt lgkmcnt(8)
  v_mfma_f32_16x16x32_bf16 a[172:175], a[160:163], a[164:167], a[172:175]
  s_waitcnt lgkmcnt(15)
  v_mfma_f32_32x32x16_bf16 v[32:47], a[248:251], v[172:175], v[32:47]
  ds_read_b64_tr_b16 a[240:241], v2 offset:7168
  ds_read_b64_tr_b16 a[242:243], v2 offset:7680
  v_dot2c_f32_bf16 v106, v172, v172
  v_dot2c_f32_bf16 v107, v173, v173
  s_waitcnt lgkmcnt(6)
  v_mfma_f32_16x16x32_bf16 a[172:175], a[160:163], a[168:171], a[172:175]
  v_mfma_f32_32x32x16_bf16 v[48:63], a[252:255], v[172:175], v[48:63]
  ds_read_b64_tr_b16 a[244:245], v3 offset:7168
  ds_read_b64_tr_b16 a[246:247], v3 offset:7680
  v_dot2c_f32_bf16 v106, v174, v174
  v_dot2c_f32_bf16 v107, v175, v175
  v_mfma_f32_16x16x32_bf16 v[80:83], a[160:163], v[172:175], v[80:83]
  s_waitcnt lgkmcnt(10)
  v_mfma_f32_32x32x16_bf16 v[32:47], a[224:227], v[176:179], v[32:47]
  ds_read_b64_tr_b16 a[248:249], v4 offset:7168
  ds_read_b64_tr_b16 a[250:251], v4 offset:7680
  s_lshl_b32 s75, s62, 7
  s_add_u32 m0, s65, 32768
  s_add_u32 s75, s75, s74
  buffer_load_dwordx4 v96, s[4:7], s75 offen offset:0 lds
  buffer_load_dwordx4 v97, s[4:7], s75 offen offset:1024 lds
  buffer_load_dwordx4 v98, s[4:7], s75 offen offset:2048 lds
  buffer_load_dwordx4 v99, s[4:7], s75 offen offset:3072 lds
  v_dot2c_f32_bf16 v106, v176, v176
  v_dot2c_f32_bf16 v107, v177, v177
  v_mfma_f32_32x32x16_bf16 v[48:63], a[228:231], v[176:179], v[48:63]
  ds_read_b64_tr_b16 a[252:253], v5 offset:7168
  s_add_u32 m0, s65, 10240
  ds_read_b64_tr_b16 a[254:255], v5 offset:7680
  buffer_load_dwordx4 v120, s[80:83], s55 offen lds
  s_add_u32 m0, s65, 12288
  s_nop 0
  buffer_load_dwordx4 v121, s[80:83], s55 offen offset:1024 lds
  v_dot2c_f32_bf16 v106, v178, v178
  v_dot2c_f32_bf16 v107, v179, v179
  v_mfma_f32_16x16x32_bf16 v[80:83], a[160:163], v[176:179], v[80:83]
  s_waitcnt lgkmcnt(8)
  v_mfma_f32_32x32x16_bf16 v[32:47], a[232:235], v[180:183], v[32:47]
  s_waitcnt vmcnt(18)
  s_barrier
  ds_read_b64_tr_b16 a[224:225], v2 offset:6144
  ds_read_b64_tr_b16 a[226:227], v2 offset:6656
  s_waitcnt vmcnt(20)
  ds_read_b128 v[192:195], v100 offset:12288
  ds_read_b128 v[196:199], v101 offset:12288
  ds_read_b128 v[200:203], v102 offset:12288
  ds_read_b128 v[204:207], v103 offset:12288
  v_dot2c_f32_bf16 v106, v180, v180
  v_dot2c_f32_bf16 v107, v181, v181
  ds_read_b64_tr_b16 a[164:165], v27 offset:6144
  ds_read_b64_tr_b16 a[166:167], v28 offset:6144
  v_mfma_f32_32x32x16_bf16 v[48:63], a[236:239], v[180:183], v[48:63]
  ds_read_b64_tr_b16 a[228:229], v3 offset:6144
  s_add_u32 m0, s65, 4096
  ds_read_b64_tr_b16 a[230:231], v3 offset:6656
  buffer_load_dwordx4 v11, s[8:11], s51 offen offset:1024 lds
  v_dot2c_f32_bf16 v106, v182, v182
  v_dot2c_f32_bf16 v107, v183, v183
  v_mfma_f32_16x16x32_bf16 v[80:83], a[160:163], v[180:183], v[80:83]
  ds_read_b64_tr_b16 a[168:169], v27 offset:9216
  ds_read_b64_tr_b16 a[170:171], v28 offset:9216
  s_waitcnt lgkmcnt(15)
  v_mfma_f32_32x32x16_bf16 v[32:47], a[240:243], v[184:187], v[32:47]
  ds_read_b64_tr_b16 a[232:233], v4 offset:6144
  ds_read_b64_tr_b16 a[234:235], v4 offset:6656
  v_dot2c_f32_bf16 v106, v184, v184
  v_dot2c_f32_bf16 v107, v185, v185
  v_mfma_f32_32x32x16_bf16 v[48:63], a[244:247], v[184:187], v[48:63]
  ds_read_b64_tr_b16 a[236:237], v5 offset:6144
  s_add_u32 m0, s65, 4096
  ds_read_b64_tr_b16 a[238:239], v5 offset:6656
  buffer_load_dwordx4 v10, s[8:11], s52 offen lds
  s_mul_i32 s53, s60, s49
  v_dot2c_f32_bf16 v106, v186, v186
  v_dot2c_f32_bf16 v107, v187, v187
  v_mfma_f32_16x16x32_bf16 v[80:83], a[160:163], v[184:187], v[80:83]
  s_waitcnt lgkmcnt(8)
  v_mfma_f32_16x16x32_bf16 a[172:175], a[160:163], a[164:167], a[172:175]
  s_waitcnt lgkmcnt(15)
  v_mfma_f32_32x32x16_bf16 v[32:47], a[248:251], v[188:191], v[32:47]
  ds_read_b64_tr_b16 a[240:241], v2 offset:9216
  ds_read_b64_tr_b16 a[242:243], v2 offset:9728
  v_dot2c_f32_bf16 v106, v188, v188
  v_dot2c_f32_bf16 v107, v189, v189
  s_waitcnt lgkmcnt(6)
  v_mfma_f32_16x16x32_bf16 a[172:175], a[160:163], a[168:171], a[172:175]
  v_mfma_f32_32x32x16_bf16 v[48:63], a[252:255], v[188:191], v[48:63]
  ds_read_b64_tr_b16 a[244:245], v3 offset:9216
  ds_read_b64_tr_b16 a[246:247], v3 offset:9728
  v_dot2c_f32_bf16 v106, v190, v190
  v_dot2c_f32_bf16 v107, v191, v191
  v_mfma_f32_16x16x32_bf16 v[80:83], a[160:163], v[188:191], v[80:83]
  s_waitcnt lgkmcnt(10)
  v_mfma_f32_32x32x16_bf16 v[32:47], a[224:227], v[192:195], v[32:47]
  ds_read_b64_tr_b16 a[248:249], v4 offset:9216
  ds_read_b64_tr_b16 a[250:251], v4 offset:9728
  s_lshl_b32 s75, s63, 7
  s_add_u32 m0, s65, 36864
  s_add_u32 s75, s75, s74
  buffer_load_dwordx4 v96, s[4:7], s75 offen offset:0 lds
  buffer_load_dwordx4 v97, s[4:7], s75 offen offset:1024 lds
  buffer_load_dwordx4 v98, s[4:7], s75 offen offset:2048 lds
  buffer_load_dwordx4 v99, s[4:7], s75 offen offset:3072 lds
  v_dot2c_f32_bf16 v106, v192, v192
  v_dot2c_f32_bf16 v107, v193, v193
  v_mfma_f32_32x32x16_bf16 v[48:63], a[228:231], v[192:195], v[48:63]
  ds_read_b64_tr_b16 a[252:253], v5 offset:9216
  s_add_u32 m0, s65, 12288
  ds_read_b64_tr_b16 a[254:255], v5 offset:9728
  buffer_load_dwordx4 v120, s[80:83], s56 offen lds
  v_dot2c_f32_bf16 v106, v194, v194
  v_dot2c_f32_bf16 v107, v195, v195
  v_mfma_f32_16x16x32_bf16 v[80:83], a[160:163], v[192:195], v[80:83]
  s_waitcnt lgkmcnt(8)
  v_mfma_f32_32x32x16_bf16 v[32:47], a[232:235], v[196:199], v[32:47]
  s_waitcnt vmcnt(15)
  s_barrier
  ds_read_b64_tr_b16 a[224:225], v2 offset:8192
  ds_read_b64_tr_b16 a[226:227], v2 offset:8704
  s_waitcnt vmcnt(17)
  ds_read_b128 v[208:211], v100 offset:16384
  ds_read_b128 v[212:215], v101 offset:16384
  ds_read_b128 v[216:219], v102 offset:16384
  ds_read_b128 v[220:223], v103 offset:16384
  v_dot2c_f32_bf16 v106, v196, v196
  v_dot2c_f32_bf16 v107, v197, v197
  s_add_u32 m0, s65, 20480
  s_mul_i32 s76, s88, 14
  buffer_load_dwordx4 v23, s[20:23], s76 offen offset:0 lds
  buffer_load_dwordx4 v24, s[20:23], s76 offen offset:1024 lds
  buffer_load_dwordx4 v25, s[20:23], s76 offen offset:2048 lds
  buffer_load_dwordx4 v26, s[20:23], s76 offen offset:3072 lds
  ds_read_b64_tr_b16 a[164:165], v27 offset:8192
  ds_read_b64_tr_b16 a[166:167], v28 offset:8192
  v_mfma_f32_32x32x16_bf16 v[48:63], a[236:239], v[196:199], v[48:63]
  ds_read_b64_tr_b16 a[228:229], v3 offset:8192
  s_add_u32 m0, s65, 6144
  ds_read_b64_tr_b16 a[230:231], v3 offset:8704
  buffer_load_dwordx4 v11, s[8:11], s52 offen offset:1024 lds
  v_dot2c_f32_bf16 v106, v198, v198
  v_dot2c_f32_bf16 v107, v199, v199
  v_mfma_f32_16x16x32_bf16 v[80:83], a[160:163], v[196:199], v[80:83]
  ds_read_b64_tr_b16 a[168:169], v27 offset:11264
  ds_read_b64_tr_b16 a[170:171], v28 offset:11264
  s_waitcnt lgkmcnt(15)
  v_mfma_f32_32x32x16_bf16 v[32:47], a[240:243], v[200:203], v[32:47]
  ds_read_b64_tr_b16 a[232:233], v4 offset:8192
  ds_read_b64_tr_b16 a[234:235], v4 offset:8704
  v_dot2c_f32_bf16 v106, v200, v200
  v_dot2c_f32_bf16 v107, v201, v201
  v_mfma_f32_32x32x16_bf16 v[48:63], a[244:247], v[200:203], v[48:63]
  ds_read_b64_tr_b16 a[236:237], v5 offset:8192
  s_add_u32 m0, s65, 6144
  ds_read_b64_tr_b16 a[238:239], v5 offset:8704
  buffer_load_dwordx4 v10, s[8:11], s53 offen lds
  s_mul_i32 s54, s61, s49
  v_dot2c_f32_bf16 v106, v202, v202
  v_dot2c_f32_bf16 v107, v203, v203
  v_mfma_f32_16x16x32_bf16 v[80:83], a[160:163], v[200:203], v[80:83]
  s_waitcnt lgkmcnt(8)
  v_mfma_f32_16x16x32_bf16 a[172:175], a[160:163], a[164:167], a[172:175]
  s_waitcnt lgkmcnt(15)
  v_mfma_f32_32x32x16_bf16 v[32:47], a[248:251], v[204:207], v[32:47]
  ds_read_b64_tr_b16 a[240:241], v2 offset:11264
  ds_read_b64_tr_b16 a[242:243], v2 offset:11776
  v_dot2c_f32_bf16 v106, v204, v204
  v_dot2c_f32_bf16 v107, v205, v205
  s_add_u32 m0, s65, 24576
  s_mul_i32 s76, s89, 14
  buffer_load_dwordx4 v23, s[20:23], s76 offen offset:0 lds
  buffer_load_dwordx4 v24, s[20:23], s76 offen offset:1024 lds
  buffer_load_dwordx4 v25, s[20:23], s76 offen offset:2048 lds
  buffer_load_dwordx4 v26, s[20:23], s76 offen offset:3072 lds
  s_waitcnt lgkmcnt(6)
  v_mfma_f32_16x16x32_bf16 a[172:175], a[160:163], a[168:171], a[172:175]
  v_mfma_f32_32x32x16_bf16 v[48:63], a[252:255], v[204:207], v[48:63]
  ds_read_b64_tr_b16 a[244:245], v3 offset:11264
  ds_read_b64_tr_b16 a[246:247], v3 offset:11776
  v_dot2c_f32_bf16 v106, v206, v206
  v_dot2c_f32_bf16 v107, v207, v207
  v_mfma_f32_16x16x32_bf16 v[80:83], a[160:163], v[204:207], v[80:83]
  s_waitcnt lgkmcnt(10)
  v_mfma_f32_32x32x16_bf16 v[32:47], a[224:227], v[208:211], v[32:47]
  ds_read_b64_tr_b16 a[248:249], v4 offset:11264
  ds_read_b64_tr_b16 a[250:251], v4 offset:11776
  v_dot2c_f32_bf16 v106, v208, v208
  v_dot2c_f32_bf16 v107, v209, v209
  v_mfma_f32_32x32x16_bf16 v[48:63], a[228:231], v[208:211], v[48:63]
  ds_read_b64_tr_b16 a[252:253], v5 offset:11264
  ds_read_b64_tr_b16 a[254:255], v5 offset:11776
  v_dot2c_f32_bf16 v106, v210, v210
  v_dot2c_f32_bf16 v107, v211, v211
  v_mfma_f32_16x16x32_bf16 v[80:83], a[160:163], v[208:211], v[80:83]
  s_waitcnt lgkmcnt(8)
  v_mfma_f32_32x32x16_bf16 v[32:47], a[232:235], v[212:215], v[32:47]
  s_waitcnt vmcnt(17)
  s_barrier
  ds_read_b64_tr_b16 a[224:225], v2 offset:10240
  ds_read_b64_tr_b16 a[226:227], v2 offset:10752
  s_waitcnt vmcnt(19)
  ds_read_b128 v[224:227], v100 offset:20480
  ds_read_b128 v[228:231], v101 offset:20480
  ds_read_b128 v[232:235], v102 offset:20480
  ds_read_b128 v[236:239], v103 offset:20480
  v_dot2c_f32_bf16 v106, v212, v212
  v_dot2c_f32_bf16 v107, v213, v213
  s_add_u32 m0, s65, 28672
  s_mul_i32 s76, s90, 14
  buffer_load_dwordx4 v23, s[20:23], s76 offen offset:0 lds
  buffer_load_dwordx4 v24, s[20:23], s76 offen offset:1024 lds
  buffer_load_dwordx4 v25, s[20:23], s76 offen offset:2048 lds
  buffer_load_dwordx4 v26, s[20:23], s76 offen offset:3072 lds
  ds_read_b64_tr_b16 a[164:165], v27 offset:10240
  ds_read_b64_tr_b16 a[166:167], v28 offset:10240
  v_mfma_f32_32x32x16_bf16 v[48:63], a[236:239], v[212:215], v[48:63]
  ds_read_b64_tr_b16 a[228:229], v3 offset:10240
  s_add_u32 m0, s65, 8192
  ds_read_b64_tr_b16 a[230:231], v3 offset:10752
  buffer_load_dwordx4 v11, s[8:11], s53 offen offset:1024 lds
  v_dot2c_f32_bf16 v106, v214, v214
  v_dot2c_f32_bf16 v107, v215, v215
  v_mfma_f32_16x16x32_bf16 v[80:83], a[160:163], v[212:215], v[80:83]
  ds_read_b64_tr_b16 a[168:169], v27 offset:13312
  ds_read_b64_tr_b16 a[170:171], v28 offset:13312
  s_waitcnt lgkmcnt(15)
  v_mfma_f32_32x32x16_bf16 v[32:47], a[240:243], v[216:219], v[32:47]
  ds_read_b64_tr_b16 a[232:233], v4 offset:10240
  ds_read_b64_tr_b16 a[234:235], v4 offset:10752
  v_dot2c_f32_bf16 v106, v216, v216
  v_dot2c_f32_bf16 v107, v217, v217
  v_mfma_f32_32x32x16_bf16 v[48:63], a[244:247], v[216:219], v[48:63]
  ds_read_b64_tr_b16 a[236:237], v5 offset:10240
  s_add_u32 m0, s65, 8192
  ds_read_b64_tr_b16 a[238:239], v5 offset:10752
  buffer_load_dwordx4 v10, s[8:11], s54 offen lds
  s_mul_i32 s55, s62, s49
  v_dot2c_f32_bf16 v106, v218, v218
  v_dot2c_f32_bf16 v107, v219, v219
  v_mfma_f32_16x16x32_bf16 v[80:83], a[160:163], v[216:219], v[80:83]
  s_waitcnt lgkmcnt(8)
  v_mfma_f32_16x16x32_bf16 a[172:175], a[160:163], a[164:167], a[172:175]
  s_waitcnt lgkmcnt(15)
  v_mfma_f32_32x32x16_bf16 v[32:47], a[248:251], v[220:223], v[32:47]
  ds_read_b64_tr_b16 a[240:241], v2 offset:13312
  ds_read_b64_tr_b16 a[242:243], v2 offset:13824
  v_dot2c_f32_bf16 v106, v220, v220
  v_dot2c_f32_bf16 v107, v221, v221
  s_waitcnt lgkmcnt(6)
  v_mfma_f32_16x16x32_bf16 a[172:175], a[160:163], a[168:171], a[172:175]
  v_mfma_f32_32x32x16_bf16 v[48:63], a[252:255], v[220:223], v[48:63]
  ds_read_b64_tr_b16 a[244:245], v3 offset:13312
  ds_read_b64_tr_b16 a[246:247], v3 offset:13824
  v_dot2c_f32_bf16 v106, v222, v222
  v_dot2c_f32_bf16 v107, v223, v223
  v_mfma_f32_16x16x32_bf16 v[80:83], a[160:163], v[220:223], v[80:83]
  s_waitcnt lgkmcnt(10)
  v_mfma_f32_32x32x16_bf16 v[32:47], a[224:227], v[224:227], v[32:47]
  ds_read_b64_tr_b16 a[248:249], v4 offset:13312
  ds_read_b64_tr_b16 a[250:251], v4 offset:13824
  v_dot2c_f32_bf16 v106, v224, v224
  v_dot2c_f32_bf16 v107, v225, v225
  s_and_b32 s75, s67, 1
  s_sub_u32 s81, s75, 1
  s_mov_b32 s80, 0
  s_sub_u32 s82, 0, s75
  s_mov_b32 s83, 0
  v_mfma_f32_32x32x16_bf16 v[48:63], a[228:231], v[224:227], v[48:63]
  ds_read_b64_tr_b16 a[252:253], v5 offset:13312
  ds_read_b64_tr_b16 a[254:255], v5 offset:13824
  v_dot2c_f32_bf16 v106, v226, v226
  v_dot2c_f32_bf16 v107, v227, v227
  v_mfma_f32_16x16x32_bf16 v[80:83], a[160:163], v[224:227], v[80:83]
  s_waitcnt lgkmcnt(8)
  v_mfma_f32_32x32x16_bf16 v[32:47], a[232:235], v[228:231], v[32:47]
  s_waitcnt vmcnt(16)
  s_barrier
  ds_read_b64_tr_b16 a[224:225], v2 offset:12288
  ds_read_b64_tr_b16 a[226:227], v2 offset:12800
  s_waitcnt vmcnt(17)
  ds_read_b128 v[240:243], v100 offset:24576
  ds_read_b128 v[244:247], v101 offset:24576
  ds_read_b128 v[248:251], v102 offset:24576
  ds_read_b128 v[252:255], v103 offset:24576
  v_dot2c_f32_bf16 v106, v228, v228
  v_dot2c_f32_bf16 v107, v229, v229
  s_add_u32 m0, s65, 32768
  s_mul_i32 s76, s91, 14
  buffer_load_dwordx4 v23, s[20:23], s76 offen offset:0 lds
  buffer_load_dwordx4 v24, s[20:23], s76 offen offset:1024 lds
  buffer_load_dwordx4 v25, s[20:23], s76 offen offset:2048 lds
  buffer_load_dwordx4 v26, s[20:23], s76 offen offset:3072 lds
  ds_read_b64_tr_b16 a[164:165], v27 offset:12288
  ds_read_b64_tr_b16 a[166:167], v28 offset:12288
  v_mfma_f32_32x32x16_bf16 v[48:63], a[236:239], v[228:231], v[48:63]
  ds_read_b64_tr_b16 a[228:229], v3 offset:12288
  s_add_u32 m0, s65, 10240
  ds_read_b64_tr_b16 a[230:231], v3 offset:12800
  buffer_load_dwordx4 v11, s[8:11], s54 offen offset:1024 lds
  v_dot2c_f32_bf16 v106, v230, v230
  v_dot2c_f32_bf16 v107, v231, v231
  v_mfma_f32_16x16x32_bf16 v[80:83], a[160:163], v[228:231], v[80:83]
  ds_read_b64_tr_b16 a[168:169], v27 offset:1024
  ds_read_b64_tr_b16 a[170:171], v28 offset:1024
  s_waitcnt lgkmcnt(15)
  v_mfma_f32_32x32x16_bf16 v[32:47], a[240:243], v[232:235], v[32:47]
  ds_read_b64_tr_b16 a[232:233], v4 offset:12288
  ds_read_b64_tr_b16 a[234:235], v4 offset:12800
  v_dot2c_f32_bf16 v106, v232, v232
  v_dot2c_f32_bf16 v107, v233, v233
  v_mfma_f32_32x32x16_bf16 v[48:63], a[244:247], v[232:235], v[48:63]
  ds_read_b64_tr_b16 a[236:237], v5 offset:12288
  s_add_u32 m0, s65, 10240
  ds_read_b64_tr_b16 a[238:239], v5 offset:12800
  buffer_load_dwordx4 v10, s[8:11], s55 offen lds
  s_mul_i32 s56, s63, s49
  v_dot2c_f32_bf16 v106, v234, v234
  v_dot2c_f32_bf16 v107, v235, v235
  v_mfma_f32_16x16x32_bf16 v[80:83], a[160:163], v[232:235], v[80:83]
  s_waitcnt lgkmcnt(8)
  v_mfma_f32_16x16x32_bf16 a[172:175], a[160:163], a[164:167], a[172:175]
  s_waitcnt lgkmcnt(15)
  v_mfma_f32_32x32x16_bf16 v[32:47], a[248:251], v[236:239], v[32:47]
  ds_read_b64_tr_b16 a[240:241], v2 offset:1024
  ds_read_b64_tr_b16 a[242:243], v2 offset:1536
  v_dot2c_f32_bf16 v106, v236, v236
  v_dot2c_f32_bf16 v107, v237, v237
  s_add_u32 s86, s67, 8
  s_cmp_eq_u32 s67, 7
  s_cselect_b32 s86, 24, s86
  s_cmp_lt_u32 s67, 7
  s_cselect_b32 s86, s67, s86
  s_cselect_b64 s[42:43], s[36:37], s[38:39]
  s_cselect_b32 s46, 0, 896
  s_waitcnt lgkmcnt(6)
  v_mfma_f32_16x16x32_bf16 a[172:175], a[160:163], a[168:171], a[172:175]
  v_mfma_f32_32x32x16_bf16 v[48:63], a[252:255], v[236:239], v[48:63]
  ds_read_b64_tr_b16 a[244:245], v3 offset:1024
  ds_read_b64_tr_b16 a[246:247], v3 offset:1536
  v_dot2c_f32_bf16 v106, v238, v238
  v_dot2c_f32_bf16 v107, v239, v239
  v_mfma_f32_16x16x32_bf16 v[80:83], a[160:163], v[236:239], v[80:83]
  s_cmp_lt_u32 s67, 7
  s_cselect_b32 s47, 0, 3584
  s_add_u32 s46, s46, 2688
  s_mul_i32 s44, s46, 448
  s_lshl_b32 s45, s86, 7
  s_mov_b32 s48, s45
  s_lshl_b32 s49, s46, 6
  v_lshl_add_u32 v131, s64, 2, v8
  s_waitcnt lgkmcnt(10)
  v_mfma_f32_32x32x16_bf16 v[32:47], a[224:227], v[240:243], v[32:47]
  ds_read_b64_tr_b16 a[248:249], v4 offset:1024
  ds_read_b64_tr_b16 a[250:251], v4 offset:1536
  v_dot2c_f32_bf16 v106, v240, v240
  v_dot2c_f32_bf16 v107, v241, v241
  v_dot2c_f32_bf16 v106, v242, v242
  v_dot2c_f32_bf16 v107, v243, v243
  v_mfma_f32_16x16x32_bf16 v[80:83], a[160:163], v[240:243], v[80:83]
  v_dot2c_f32_bf16 v106, v244, v244
  v_dot2c_f32_bf16 v107, v245, v245
  v_dot2c_f32_bf16 v106, v246, v246
  v_dot2c_f32_bf16 v107, v247, v247
  v_mfma_f32_16x16x32_bf16 v[80:83], a[160:163], v[244:247], v[80:83]
  v_accvgpr_read_b32 v128, a172
  v_cvt_pk_bf16_f32 v129, v128, v128
  v_and_b32 v129, 0xffff0000, v129
  v_sub_f32 v128, v128, v129
  v_cvt_pk_bf16_f32 v128, v129, v128
  v_mfma_f32_32x32x16_bf16 v[48:63], a[228:231], v[240:243], v[48:63]
  ds_read_b64_tr_b16 a[252:253], v5 offset:1024
  ds_read_b64_tr_b16 a[254:255], v5 offset:1536
  v_dot2c_f32_bf16 v106, v248, v248
  v_dot2c_f32_bf16 v107, v249, v249
  v_dot2c_f32_bf16 v106, v250, v250
  v_dot2c_f32_bf16 v107, v251, v251
  v_mfma_f32_16x16x32_bf16 v[80:83], a[160:163], v[248:251], v[80:83]
  v_dot2c_f32_bf16 v106, v252, v252
  v_dot2c_f32_bf16 v107, v253, v253
  v_dot2c_f32_bf16 v106, v254, v254
  v_dot2c_f32_bf16 v107, v255, v255
  v_mfma_f32_16x16x32_bf16 v[80:83], a[160:163], v[252:255], v[80:83]
  ds_write_b32 v131, v128 offset:19456
  v_lshlrev_b32 v130, 3, v22
  s_waitcnt lgkmcnt(9)
  v_mfma_f32_32x32x16_bf16 v[32:47], a[232:235], v[244:247], v[32:47]
  s_waitcnt vmcnt(36)
  s_waitcnt lgkmcnt(0)
  s_barrier
  ds_read_b64_tr_b16 a[224:225], v2 offset:0
  ds_read_b64_tr_b16 a[226:227], v2 offset:512
  s_add_u32 m0, s65, 36864
  s_mul_i32 s76, s92, 14
  buffer_load_dwordx4 v23, s[20:23], s76 offen offset:0 lds
  buffer_load_dwordx4 v24, s[20:23], s76 offen offset:1024 lds
  buffer_load_dwordx4 v25, s[20:23], s76 offen offset:2048 lds
  buffer_load_dwordx4 v26, s[20:23], s76 offen offset:3072 lds
  ds_read_b128 v[132:135], v130 offset:19968
  ds_read_b128 v[128:131], v130 offset:19456
  v_mfma_f32_32x32x16_bf16 v[48:63], a[236:239], v[244:247], v[48:63]
  ds_read_b64_tr_b16 a[228:229], v3 offset:0
  s_add_u32 m0, s65, 12288
  ds_read_b64_tr_b16 a[230:231], v3 offset:512
  buffer_load_dwordx4 v11, s[8:11], s55 offen offset:1024 lds
  v_add_f32 v106, v106, v107
  v_mov_b32 v104, v80
  v_mov_b32 v105, v104
  v_mov_b32 v107, v106
  s_nop 0
  v_permlane32_swap_b32 v104, v105
  v_permlane32_swap_b32 v106, v107
  v_add_f32 v104, v104, v105
  v_add_f32 v106, v106, v107
  v_mul_f32 v104, 0x3b124925, v104
  v_mul_f32 v106, 0x3b124925, v106
  s_waitcnt lgkmcnt(11)
  v_mfma_f32_32x32x16_bf16 v[32:47], a[240:243], v[248:251], v[32:47]
  ds_read_b64_tr_b16 a[232:233], v4 offset:0
  ds_read_b64_tr_b16 a[234:235], v4 offset:512
  v_fma_f32 v106, -v104, v104, v106
  v_max_f32 v106, 0, v106
  v_cvt_pk_bf16_f32 v105, v104, v106
  v_and_b32 v106, 0xffff0000, v105
  v_lshlrev_b32 v104, 16, v105
  v_add_f32 v106, 0x3727c5ac, v106
  v_cvt_pk_bf16_f32 v106, v106, v106
  v_and_b32 v106, 0xffff0000, v106
  v_sqrt_f32 v106, v106
  v_xor_b32 v104, 0x80000000, v104
  v_cvt_pk_bf16_f32 v106, v106, v106
  v_mfma_f32_32x32x16_bf16 v[48:63], a[244:247], v[248:251], v[48:63]
  ds_read_b64_tr_b16 a[236:237], v5 offset:0
  s_add_u32 m0, s65, 12288
  ds_read_b64_tr_b16 a[238:239], v5 offset:512
  buffer_load_dwordx4 v10, s[8:11], s56 offen lds
  v_and_b32 v107, 0xffff0000, v106
  v_rcp_f32 v6, v107
  v_and_b32 v106, 0xffff, v106
  v_cvt_pk_bf16_f32 v104, v104, v104
  v_cmp_gt_u32 vcc, 32, v1
  s_mov_b32 s79, 0x3f317218
  v_mul_f32 v7, 0x3fb8aa3b, v6
  v_cndmask_b32 v16, v106, v104, vcc
  v_cndmask_b32 v17, 0, v104, vcc
  v_cndmask_b32 v18, 0, v104, vcc
  v_cndmask_b32 v19, 0, v104, vcc
  v_cmp_gt_u32 vcc, 32, v1
  s_waitcnt lgkmcnt(6)
  s_nop 0
  v_cndmask_b32 v128, v12, v128, vcc
  v_cndmask_b32 v132, v13, v132, vcc
  s_waitcnt lgkmcnt(11)
  v_mfma_f32_32x32x16_bf16 v[32:47], a[248:251], v[252:255], v[32:47]
  ds_read_b64_tr_b16 a[240:241], v2 offset:3072
  ds_read_b64_tr_b16 a[242:243], v2 offset:3584
  v_and_b32 v96, 12, v143
  buffer_load_dword v29, v96, s[32:35], 0 offen sc1
  v_mfma_f32_32x32x16_bf16 v[32:47], v[128:131], v[16:19], v[32:47]
  v_mfma_f32_32x32x16_bf16 v[48:63], a[252:255], v[252:255], v[48:63]
  ds_read_b64_tr_b16 a[244:245], v3 offset:3072
  ds_read_b64_tr_b16 a[246:247], v3 offset:3584
  s_cmp_eq_u32 s69, 7
  s_cselect_b64 s[20:21], s[40:41], s[20:21]
  s_cselect_b32 s22, 401408, s22
  v_mfma_f32_32x32x16_bf16 v[48:63], v[132:135], v[16:19], v[48:63]
  s_waitcnt vmcnt(50)
  v_mov_b32 v12, v14
  v_mov_b32 v13, v15
  s_nop 1
  v_fma_f32 v64, v32, v7, s78
  v_fma_f32 v65, v33, v7, s78
  v_fma_f32 v66, v34, v7, s78
  v_fma_f32 v67, v35, v7, s78
  v_fma_f32 v68, v36, v7, s78
  v_fma_f32 v69, v37, v7, s78
  v_fma_f32 v70, v38, v7, s78
  v_fma_f32 v71, v39, v7, s78
  v_fma_f32 v72, v40, v7, s78
  v_fma_f32 v73, v41, v7, s78
  v_fma_f32 v74, v42, v7, s78
  v_fma_f32 v75, v43, v7, s78
  v_fma_f32 v76, v44, v7, s78
  v_fma_f32 v77, v45, v7, s78
  v_fma_f32 v78, v46, v7, s78
  v_fma_f32 v79, v47, v7, s78
  s_waitcnt lgkmcnt(8)
  v_mfma_f32_32x32x16_bf16 v[32:47], a[224:227], v[144:147], 0
  ds_read_b64_tr_b16 a[248:249], v4 offset:3072
  ds_read_b64_tr_b16 a[250:251], v4 offset:3584
  v_mul_f32 v80, v6, v48
  v_mul_f32 v81, v6, v49
  v_mul_f32 v82, v6, v50
  v_mul_f32 v83, v6, v51
  v_mul_f32 v84, v6, v52
  v_mul_f32 v85, v6, v53
  v_mul_f32 v86, v6, v54
  v_mul_f32 v87, v6, v55
  v_mul_f32 v88, v6, v56
  v_mul_f32 v89, v6, v57
  v_mul_f32 v90, v6, v58
  v_mul_f32 v91, v6, v59
  v_mul_f32 v92, v6, v60
  v_mul_f32 v93, v6, v61
  v_mul_f32 v94, v6, v62
  v_mul_f32 v95, v6, v63
  v_exp_f32 v96, v64 clamp
  v_exp_f32 v97, v65 clamp
  v_max_f32 v64, s78, v64
  v_max_f32 v65, s78, v65
  v_lshrrev_b32 v128, 4, v1
  ds_read_b64_tr_b16 a[164:165], v27 offset:0
  ds_read_b64_tr_b16 a[166:167], v28 offset:0
  v_mfma_f32_32x32x16_bf16 v[48:63], a[228:231], v[144:147], 0
  ds_read_b64_tr_b16 a[252:253], v5 offset:3072
  ds_read_b64_tr_b16 a[254:255], v5 offset:3584
  v_fma_f32 v96, v64, s79, v96
  v_fma_f32 v97, v65, s79, v97
  v_cvt_pk_bf16_f32 v64, v96, v97
  v_bfe_u32 v129, v1, 2, 2
  v_lshl_add_u32 v128, v128, 3, v129
  ds_read_b64_tr_b16 a[168:169], v27 offset:3072
  ds_read_b64_tr_b16 a[170:171], v28 offset:3072
  s_waitcnt lgkmcnt(12)
  v_mfma_f32_32x32x16_bf16 v[32:47], a[232:235], v[148:151], v[32:47]
  s_waitcnt vmcnt(35)
  s_barrier
  ds_read_b64_tr_b16 a[224:225], v2 offset:2048
  ds_read_b64_tr_b16 a[226:227], v2 offset:2560
  v_exp_f32 v98, v66 clamp
  v_exp_f32 v99, v67 clamp
  v_max_f32 v66, s78, v66
  v_max_f32 v67, s78, v67
  v_lshlrev_b32 v128, 7, v128
  s_waitcnt vmcnt(25)
  v_mfma_f32_32x32x16_bf16 v[48:63], a[236:239], v[148:151], v[48:63]
  ds_read_b64_tr_b16 a[228:229], v3 offset:2048
  s_add_u32 m0, s65, 0
  ds_read_b64_tr_b16 a[230:231], v3 offset:2560
  buffer_load_dwordx4 v11, s[8:11], s56 offen offset:1024 lds
  s_mov_b64 s[8:9], s[42:43]
  s_mov_b32 s10, s44
  s_mul_i32 s50, s57, s49
  v_mad_u32_u24 v10, v20, s46, v21
  v_add_u32 v10, s45, v10
  v_fma_f32 v98, v66, s79, v98
  v_fma_f32 v99, v67, s79, v99
  v_cvt_pk_bf16_f32 v65, v98, v99
  v_bfe_u32 v130, v1, 1, 1
  v_xor_b32 v129, v129, v130
  s_waitcnt lgkmcnt(8)
  v_mfma_f32_16x16x32_bf16 a[172:175], a[160:163], a[164:167], 0
  s_waitcnt lgkmcnt(12)
  v_mfma_f32_32x32x16_bf16 v[32:47], a[240:243], v[152:155], v[32:47]
  ds_read_b64_tr_b16 a[232:233], v4 offset:2048
  ds_read_b64_tr_b16 a[234:235], v4 offset:2560
  v_exp_f32 v96, v68 clamp
  v_exp_f32 v97, v69 clamp
  v_max_f32 v68, s78, v68
  v_max_f32 v69, s78, v69
  v_lshl_add_u32 v128, v129, 4, v128
  s_waitcnt lgkmcnt(6)
  v_mfma_f32_16x16x32_bf16 a[172:175], a[160:163], a[168:171], a[172:175]
  v_mfma_f32_32x32x16_bf16 v[48:63], a[244:247], v[152:155], v[48:63]
  ds_read_b64_tr_b16 a[236:237], v5 offset:2048
  s_add_u32 m0, s65, 0
  ds_read_b64_tr_b16 a[238:239], v5 offset:2560
  buffer_load_dwordx4 v10, s[8:11], s50 offen lds
  s_lshr_b32 s77, s49, 1
  s_sub_u32 s77, s77, 1024
  v_add_u32 v11, s77, v10
  s_mul_i32 s51, s58, s49
  v_fma_f32 v96, v68, s79, v96
  v_fma_f32 v97, v69, s79, v97
  v_cvt_pk_bf16_f32 v66, v96, v97
  v_and_b32 v130, 1, v1
  v_lshl_add_u32 v128, v130, 3, v128
  ds_read_b64_tr_b16 a[164:165], v27 offset:2048
  ds_read_b64_tr_b16 a[166:167], v28 offset:2048
  s_waitcnt lgkmcnt(12)
  v_mfma_f32_32x32x16_bf16 v[32:47], a[248:251], v[156:159], v[32:47]
  ds_read_b64_tr_b16 a[240:241], v2 offset:5120
  ds_read_b64_tr_b16 a[242:243], v2 offset:5632
  v_exp_f32 v98, v70 clamp
  v_exp_f32 v99, v71 clamp
  v_max_f32 v70, s78, v70
  v_max_f32 v71, s78, v71
  v_add_u32 v128, 16384, v128
  ds_read_b64_tr_b16 a[168:169], v27 offset:5120
  ds_read_b64_tr_b16 a[170:171], v28 offset:5120
  v_mfma_f32_32x32x16_bf16 v[48:63], a[252:255], v[156:159], v[48:63]
  ds_read_b64_tr_b16 a[244:245], v3 offset:5120
  ds_read_b64_tr_b16 a[246:247], v3 offset:5632
  s_mov_b32 s18, s47
  buffer_load_ushort v14, v22, s[16:19], s48 offen
  buffer_load_ushort v15, v22, s[16:19], s48 offen offset:64
  v_fma_f32 v98, v70, s79, v98
  v_fma_f32 v99, v71, s79, v99
  v_cvt_pk_bf16_f32 v67, v98, v99
  ds_read_b64_tr_b16 a[0:1], v27 offset:20480
  ds_read_b64_tr_b16 a[2:3], v27 offset:21504
  s_waitcnt lgkmcnt(14)
  v_mfma_f32_32x32x16_bf16 v[32:47], a[224:227], v[160:163], v[32:47]
  ds_read_b64_tr_b16 a[248:249], v4 offset:5120
  ds_read_b64_tr_b16 a[250:251], v4 offset:5632
  v_exp_f32 v96, v72 clamp
  v_exp_f32 v97, v73 clamp
  v_max_f32 v72, s78, v72
  v_max_f32 v73, s78, v73
  ds_read_b64_tr_b16 a[4:5], v28 offset:20480
  ds_read_b64_tr_b16 a[6:7], v28 offset:21504
  s_waitcnt lgkmcnt(12)
  v_mfma_f32_16x16x32_bf16 a[172:175], a[160:163], a[164:167], a[172:175]
  v_mfma_f32_32x32x16_bf16 v[48:63], a[228:231], v[160:163], v[48:63]
  ds_read_b64_tr_b16 a[252:253], v5 offset:5120
  ds_read_b64_tr_b16 a[254:255], v5 offset:5632
  v_fma_f32 v96, v72, s79, v96
  v_fma_f32 v97, v73, s79, v97
  v_cvt_pk_bf16_f32 v68, v96, v97
  ds_read_b64_tr_b16 a[8:9], v27 offset:22528
  ds_read_b64_tr_b16 a[10:11], v27 offset:23552
  s_waitcnt lgkmcnt(12)
  v_mfma_f32_16x16x32_bf16 a[172:175], a[160:163], a[168:171], a[172:175]
  s_waitcnt lgkmcnt(15)
  v_mfma_f32_32x32x16_bf16 v[32:47], a[232:235], v[164:167], v[32:47]
  s_waitcnt vmcnt(28)
  s_barrier
  ds_read_b64_tr_b16 a[224:225], v2 offset:4096
  ds_read_b64_tr_b16 a[226:227], v2 offset:4608
  v_exp_f32 v98, v74 clamp
  v_exp_f32 v99, v75 clamp
  v_max_f32 v74, s78, v74
  v_max_f32 v75, s78, v75
  ds_read_b64_tr_b16 a[12:13], v28 offset:22528
  ds_read_b64_tr_b16 a[14:15], v28 offset:23552
  ds_read_b64_tr_b16 a[164:165], v27 offset:4096
  ds_read_b64_tr_b16 a[166:167], v28 offset:4096
  v_mfma_f32_32x32x16_bf16 v[48:63], a[236:239], v[164:167], v[48:63]
  ds_read_b64_tr_b16 a[228:229], v3 offset:4096
  s_add_u32 m0, s65, 2048
  ds_read_b64_tr_b16 a[230:231], v3 offset:4608
  buffer_load_dwordx4 v11, s[8:11], s50 offen offset:1024 lds
  v_fma_f32 v98, v74, s79, v98
  v_fma_f32 v99, v75, s79, v99
  v_cvt_pk_bf16_f32 v69, v98, v99
  s_waitcnt vmcnt(24)
  ds_read_b64_tr_b16 a[16:17], v27 offset:24576
  ds_read_b64_tr_b16 a[18:19], v27 offset:25600
  ds_read_b64_tr_b16 a[168:169], v27 offset:7168
  ds_read_b64_tr_b16 a[170:171], v28 offset:7168
  s_waitcnt lgkmcnt(15)
  v_mfma_f32_32x32x16_bf16 v[32:47], a[240:243], v[168:171], v[32:47]
  ds_read_b64_tr_b16 a[232:233], v4 offset:4096
  ds_read_b64_tr_b16 a[234:235], v4 offset:4608
  v_exp_f32 v96, v76 clamp
  v_exp_f32 v97, v77 clamp
  v_max_f32 v76, s78, v76
  v_max_f32 v77, s78, v77
  ds_read_b64_tr_b16 a[20:21], v28 offset:24576
  ds_read_b64_tr_b16 a[22:23], v28 offset:25600
  v_mfma_f32_32x32x16_bf16 v[48:63], a[244:247], v[168:171], v[48:63]
  ds_read_b64_tr_b16 a[236:237], v5 offset:4096
  s_add_u32 m0, s65, 2048
  ds_read_b64_tr_b16 a[238:239], v5 offset:4608
  buffer_load_dwordx4 v10, s[8:11], s51 offen lds
  s_mul_i32 s52, s59, s49
  v_fma_f32 v96, v76, s79, v96
  v_fma_f32 v97, v77, s79, v97
  v_cvt_pk_bf16_f32 v70, v96, v97
  ds_read_b64_tr_b16 a[24:25], v27 offset:26624
  ds_read_b64_tr_b16 a[26:27], v27 offset:27648
  s_waitcnt lgkmcnt(14)
  v_mfma_f32_16x16x32_bf16 a[172:175], a[160:163], a[164:167], a[172:175]
  s_waitcnt lgkmcnt(15)
  v_mfma_f32_32x32x16_bf16 v[32:47], a[248:251], v[172:175], v[32:47]
  ds_read_b64_tr_b16 a[240:241], v2 offset:7168
  ds_read_b64_tr_b16 a[242:243], v2 offset:7680
  v_exp_f32 v98, v78 clamp
  v_exp_f32 v99, v79 clamp
  v_max_f32 v78, s78, v78
  v_max_f32 v79, s78, v79
  ds_read_b64_tr_b16 a[28:29], v28 offset:26624
  ds_read_b64_tr_b16 a[30:31], v28 offset:27648
  s_waitcnt lgkmcnt(12)
  v_mfma_f32_16x16x32_bf16 a[172:175], a[160:163], a[168:171], a[172:175]
  v_mfma_f32_32x32x16_bf16 v[48:63], a[252:255], v[172:175], v[48:63]
  ds_read_b64_tr_b16 a[244:245], v3 offset:7168
  ds_read_b64_tr_b16 a[246:247], v3 offset:7680
  v_fma_f32 v98, v78, s79, v98
  v_fma_f32 v99, v79, s79, v99
  v_cvt_pk_bf16_f32 v71, v98, v99
  s_waitcnt lgkmcnt(15)
  s_waitcnt lgkmcnt(15)
  v_mfma_f32_32x32x16_bf16 v[32:47], a[224:227], v[176:179], v[32:47]
  ds_read_b64_tr_b16 a[248:249], v4 offset:7168
  ds_read_b64_tr_b16 a[250:251], v4 offset:7680
  v_cndmask_b32 v80, v80, 1.0, s[82:83]
  v_cndmask_b32 v92, v92, 1.0, s[80:81]
  v_cvt_pk_bf16_f32 v72, v80, v81
  v_cvt_pk_bf16_f32 v73, v82, v83
  v_mfma_f32_32x32x16_bf16 v[48:63], a[228:231], v[176:179], v[48:63]
  ds_read_b64_tr_b16 a[252:253], v5 offset:7168
  ds_read_b64_tr_b16 a[254:255], v5 offset:7680
  v_cvt_pk_bf16_f32 v74, v84, v85
  v_cvt_pk_bf16_f32 v75, v86, v87
  v_cvt_pk_bf16_f32 v76, v88, v89
  v_cvt_pk_bf16_f32 v77, v90, v91
  s_waitcnt lgkmcnt(12)
  v_mfma_f32_32x32x16_bf16 v[32:47], a[232:235], v[180:183], v[32:47]
  s_waitcnt vmcnt(20)
  s_barrier
  ds_read_b64_tr_b16 a[224:225], v2 offset:6144
  ds_read_b64_tr_b16 a[226:227], v2 offset:6656
  v_cvt_pk_bf16_f32 v78, v92, v93
  v_cvt_pk_bf16_f32 v79, v94, v95
  v_and_b32 v100, 31, v1
  v_and_b32 v101, 7, v1
  ds_read_b64_tr_b16 a[164:165], v27 offset:6144
  ds_read_b64_tr_b16 a[166:167], v28 offset:6144
  v_mfma_f32_32x32x16_bf16 v[48:63], a[236:239], v[180:183], v[48:63]
  ds_read_b64_tr_b16 a[228:229], v3 offset:6144
  s_add_u32 m0, s65, 4096
  ds_read_b64_tr_b16 a[230:231], v3 offset:6656
  buffer_load_dwordx4 v11, s[8:11], s51 offen offset:1024 lds
  v_lshlrev_b32 v100, 7, v100
  v_lshl_add_u32 v100, v101, 4, v100
  v_lshrrev_b32 v101, 5, v1
  v_lshl_add_u32 v100, v101, 3, v100
  ds_read_b64_tr_b16 a[168:169], v27 offset:9216
  ds_read_b64_tr_b16 a[170:171], v28 offset:9216
  s_waitcnt lgkmcnt(12)
  v_mfma_f32_32x32x16_bf16 v[32:47], a[240:243], v[184:187], v[32:47]
  ds_read_b64_tr_b16 a[232:233], v4 offset:6144
  ds_read_b64_tr_b16 a[234:235], v4 offset:6656
  s_add_u32 s75, s65, 16384
  v_add_u32 v100, s75, v100
  v_xor_b32 v101, 0, v100
  ds_write_b64 v101, v[64:65]
  v_mfma_f32_32x32x16_bf16 v[48:63], a[244:247], v[184:187], v[48:63]
  ds_read_b64_tr_b16 a[236:237], v5 offset:6144
  s_add_u32 m0, s65, 4096
  ds_read_b64_tr_b16 a[238:239], v5 offset:6656
  buffer_load_dwordx4 v10, s[8:11], s52 offen lds
  s_mul_i32 s53, s60, s49
  v_xor_b32 v102, 16, v100
  ds_write_b64 v102, v[66:67]
  v_xor_b32 v101, 32, v100
  ds_write_b64 v101, v[68:69]
  s_waitcnt lgkmcnt(11)
  v_mfma_f32_16x16x32_bf16 a[172:175], a[160:163], a[164:167], a[172:175]
  s_waitcnt lgkmcnt(15)
  v_mfma_f32_32x32x16_bf16 v[32:47], a[248:251], v[188:191], v[32:47]
  ds_read_b64_tr_b16 a[240:241], v2 offset:9216
  ds_read_b64_tr_b16 a[242:243], v2 offset:9728
  v_xor_b32 v102, 48, v100
  ds_write_b64 v102, v[70:71]
  v_xor_b32 v101, 64, v100
  ds_write_b64 v101, v[72:73]
  s_waitcnt lgkmcnt(11)
  v_mfma_f32_16x16x32_bf16 a[172:175], a[160:163], a[168:171], a[172:175]
  v_mfma_f32_32x32x16_bf16 v[48:63], a[252:255], v[188:191], v[48:63]
  ds_read_b64_tr_b16 a[244:245], v3 offset:9216
  ds_read_b64_tr_b16 a[246:247], v3 offset:9728
  v_xor_b32 v102, 80, v100
  ds_write_b64 v102, v[74:75]
  v_xor_b32 v101, 96, v100
  ds_write_b64 v101, v[76:77]
  s_waitcnt lgkmcnt(15)
  v_mfma_f32_32x32x16_bf16 v[32:47], a[224:227], v[192:195], v[32:47]
  ds_read_b64_tr_b16 a[248:249], v4 offset:9216
  ds_read_b64_tr_b16 a[250:251], v4 offset:9728
  v_xor_b32 v102, 112, v100
  ds_write_b64 v102, v[78:79]
  s_and_b32 s75, s64, 1
  s_lshl_b32 s75, s75, 5
  v_xor_b32 v129, s75, v128
  v_mfma_f32_32x32x16_bf16 v[48:63], a[228:231], v[192:195], v[48:63]
  ds_read_b64_tr_b16 a[252:253], v5 offset:9216
  ds_read_b64_tr_b16 a[254:255], v5 offset:9728
  s_lshr_b32 s75, s64, 1
  s_lshl_b32 s75, s75, 5
  s_add_u32 s75, s75, 64
  v_xor_b32 v130, s75, v128
  v_xor_b32 v128, 64, v129
  v_xor_b32 v131, 64, v130
  v_add_u32 v132, 81920, v129
  v_add_u32 v133, 81920, v128
  v_add_u32 v134, 81920, v130
  v_add_u32 v135, 81920, v131
  s_lshl_b32 s74, s67, 4
  s_add_u32 s74, s74, s66
  s_lshl_b32 s74, s74, 12
  s_lshl_b32 s75, s64, 10
  s_add_u32 s74, s74, s75
  s_add_u32 s74, s74, 9175040
  s_waitcnt lgkmcnt(15)
  v_mfma_f32_32x32x16_bf16 v[32:47], a[232:235], v[196:199], v[32:47]
  s_waitcnt vmcnt(16)
  s_waitcnt lgkmcnt(2)
  s_barrier
  ds_read_b64_tr_b16 a[224:225], v2 offset:8192
  ds_read_b64_tr_b16 a[226:227], v2 offset:8704
  ds_read_b64_tr_b16 v[96:97], v129 offset:0
  ds_read_b64_tr_b16 v[98:99], v128 offset:512
  ds_read_b64_tr_b16 v[100:101], v130 offset:0
  ds_read_b64_tr_b16 v[102:103], v131 offset:512
  ds_read_b64_tr_b16 a[164:165], v27 offset:8192
  ds_read_b64_tr_b16 a[166:167], v28 offset:8192
  v_mfma_f32_32x32x16_bf16 v[48:63], a[236:239], v[196:199], v[48:63]
  ds_read_b64_tr_b16 a[228:229], v3 offset:8192
  s_add_u32 m0, s65, 6144
  ds_read_b64_tr_b16 a[230:231], v3 offset:8704
  buffer_load_dwordx4 v11, s[8:11], s52 offen offset:1024 lds
  ds_read_b64_tr_b16 v[104:105], v129 offset:40960
  ds_read_b64_tr_b16 v[106:107], v128 offset:41472
  ds_read_b64_tr_b16 v[108:109], v130 offset:40960
  ds_read_b64_tr_b16 v[110:111], v131 offset:41472
  ds_read_b64_tr_b16 a[168:169], v27 offset:11264
  ds_read_b64_tr_b16 a[170:171], v28 offset:11264
  s_waitcnt lgkmcnt(15)
  v_mfma_f32_32x32x16_bf16 v[32:47], a[240:243], v[200:203], v[32:47]
  ds_read_b64_tr_b16 a[232:233], v4 offset:8192
  ds_read_b64_tr_b16 a[234:235], v4 offset:8704
  ds_read_b64_tr_b16 v[112:113], v132 offset:0
  ds_read_b64_tr_b16 v[114:115], v133 offset:512
  ds_read_b64_tr_b16 v[116:117], v134 offset:0
  ds_read_b64_tr_b16 v[118:119], v135 offset:512
  v_mfma_f32_32x32x16_bf16 v[48:63], a[244:247], v[200:203], v[48:63]
  ds_read_b64_tr_b16 a[236:237], v5 offset:8192
  s_add_u32 m0, s65, 6144
  ds_read_b64_tr_b16 a[238:239], v5 offset:8704
  buffer_load_dwordx4 v10, s[8:11], s53 offen lds
  s_mul_i32 s54, s61, s49
  ds_read_b64_tr_b16 v[120:121], v132 offset:40960
  ds_read_b64_tr_b16 v[122:123], v133 offset:41472
  ds_read_b64_tr_b16 v[124:125], v134 offset:40960
  ds_read_b64_tr_b16 v[126:127], v135 offset:41472
  s_waitcnt lgkmcnt(15)
  v_mfma_f32_16x16x32_bf16 a[172:175], a[160:163], a[164:167], a[172:175]
  s_waitcnt lgkmcnt(15)
  v_mfma_f32_32x32x16_bf16 v[32:47], a[248:251], v[204:207], v[32:47]
  ds_read_b64_tr_b16 a[240:241], v2 offset:11264
  ds_read_b64_tr_b16 a[242:243], v2 offset:11776
  s_add_u32 m0, s65, 20480
  s_mul_i32 s76, s93, 14
  buffer_load_dwordx4 v23, s[20:23], s76 offen offset:0 lds
  buffer_load_dwordx4 v24, s[20:23], s76 offen offset:1024 lds
  buffer_load_dwordx4 v25, s[20:23], s76 offen offset:2048 lds
  buffer_load_dwordx4 v26, s[20:23], s76 offen offset:3072 lds
  s_waitcnt lgkmcnt(14)
  v_mfma_f32_16x16x32_bf16 a[172:175], a[160:163], a[168:171], a[172:175]
  v_mfma_f32_32x32x16_bf16 v[48:63], a[252:255], v[204:207], v[48:63]
  ds_read_b64_tr_b16 a[244:245], v3 offset:11264
  ds_read_b64_tr_b16 a[246:247], v3 offset:11776
  s_waitcnt vmcnt(29)
  ds_read_b64_tr_b16 a[32:33], v27 offset:28672
  ds_read_b64_tr_b16 a[34:35], v27 offset:29696
  ds_read_b64_tr_b16 a[36:37], v28 offset:28672
  ds_read_b64_tr_b16 a[38:39], v28 offset:29696
  s_waitcnt lgkmcnt(15)
  v_mfma_f32_32x32x16_bf16 v[32:47], a[224:227], v[208:211], v[32:47]
  ds_read_b64_tr_b16 a[248:249], v4 offset:11264
  ds_read_b64_tr_b16 a[250:251], v4 offset:11776
  s_waitcnt lgkmcnt(15)
  v_mfma_f32_16x16x32_bf16 v[64:67], v[96:99], v[100:103], 0
  ds_read_b64_tr_b16 a[40:41], v27 offset:30720
  ds_read_b64_tr_b16 a[42:43], v27 offset:31744
  ds_read_b64_tr_b16 a[44:45], v28 offset:30720
  ds_read_b64_tr_b16 a[46:47], v28 offset:31744
  s_waitcnt lgkmcnt(15)
  v_mfma_f32_32x32x16_bf16 v[48:63], a[228:231], v[208:211], v[48:63]
  ds_read_b64_tr_b16 a[252:253], v5 offset:11264
  ds_read_b64_tr_b16 a[254:255], v5 offset:11776
  s_waitcnt lgkmcnt(15)
  v_mfma_f32_16x16x32_bf16 v[64:67], v[104:107], v[108:111], v[64:67]
  s_waitcnt lgkmcnt(15)
  v_mfma_f32_32x32x16_bf16 v[32:47], a[232:235], v[212:215], v[32:47]
  s_waitcnt vmcnt(16)
  s_barrier
  ds_read_b64_tr_b16 a[224:225], v2 offset:10240
  ds_read_b64_tr_b16 a[226:227], v2 offset:10752
  s_waitcnt lgkmcnt(15)
  v_mfma_f32_16x16x32_bf16 v[64:67], v[112:115], v[116:119], v[64:67]
  ds_read_b64_tr_b16 a[164:165], v27 offset:10240
  ds_read_b64_tr_b16 a[166:167], v28 offset:10240
  v_mfma_f32_32x32x16_bf16 v[48:63], a[236:239], v[212:215], v[48:63]
  ds_read_b64_tr_b16 a[228:229], v3 offset:10240
  s_add_u32 m0, s65, 8192
  ds_read_b64_tr_b16 a[230:231], v3 offset:10752
  buffer_load_dwordx4 v11, s[8:11], s53 offen offset:1024 lds
  s_waitcnt lgkmcnt(15)
  v_mfma_f32_16x16x32_bf16 v[64:67], v[120:123], v[124:127], v[64:67]
  ds_read_b64_tr_b16 a[168:169], v27 offset:13312
  ds_read_b64_tr_b16 a[170:171], v28 offset:13312
  s_waitcnt lgkmcnt(15)
  v_mfma_f32_32x32x16_bf16 v[32:47], a[240:243], v[216:219], v[32:47]
  ds_read_b64_tr_b16 a[232:233], v4 offset:10240
  ds_read_b64_tr_b16 a[234:235], v4 offset:10752
  s_add_u32 m0, s65, 24576
  s_mul_i32 s76, s94, 14
  buffer_load_dwordx4 v23, s[20:23], s76 offen offset:0 lds
  buffer_load_dwordx4 v24, s[20:23], s76 offen offset:1024 lds
  buffer_load_dwordx4 v25, s[20:23], s76 offen offset:2048 lds
  buffer_load_dwordx4 v26, s[20:23], s76 offen offset:3072 lds
  v_mfma_f32_32x32x16_bf16 v[48:63], a[244:247], v[216:219], v[48:63]
  ds_read_b64_tr_b16 a[236:237], v5 offset:10240
  s_add_u32 m0, s65, 8192
  ds_read_b64_tr_b16 a[238:239], v5 offset:10752
  buffer_load_dwordx4 v10, s[8:11], s54 offen lds
  s_mul_i32 s55, s62, s49
  buffer_store_dwordx4 v[64:67], v8, s[12:15], s74 offen sc1
  s_waitcnt vmcnt(30)
  ds_read_b64_tr_b16 a[48:49], v27 offset:32768
  ds_read_b64_tr_b16 a[50:51], v27 offset:33792
  ds_read_b64_tr_b16 a[52:53], v28 offset:32768
  ds_read_b64_tr_b16 a[54:55], v28 offset:33792
  s_waitcnt lgkmcnt(12)
  v_mfma_f32_16x16x32_bf16 a[172:175], a[160:163], a[164:167], a[172:175]
  s_waitcnt lgkmcnt(15)
  v_mfma_f32_32x32x16_bf16 v[32:47], a[248:251], v[220:223], v[32:47]
  ds_read_b64_tr_b16 a[240:241], v2 offset:13312
  ds_read_b64_tr_b16 a[242:243], v2 offset:13824
  ds_read_b64_tr_b16 a[56:57], v27 offset:34816
  ds_read_b64_tr_b16 a[58:59], v27 offset:35840
  ds_read_b64_tr_b16 a[60:61], v28 offset:34816
  ds_read_b64_tr_b16 a[62:63], v28 offset:35840
  s_waitcnt lgkmcnt(15)
  s_waitcnt lgkmcnt(14)
  v_mfma_f32_16x16x32_bf16 a[172:175], a[160:163], a[168:171], a[172:175]
  v_mfma_f32_32x32x16_bf16 v[48:63], a[252:255], v[220:223], v[48:63]
  ds_read_b64_tr_b16 a[244:245], v3 offset:13312
  ds_read_b64_tr_b16 a[246:247], v3 offset:13824
  s_add_u32 m0, s65, 28672
  s_mul_i32 s76, s95, 14
  buffer_load_dwordx4 v23, s[20:23], s76 offen offset:0 lds
  buffer_load_dwordx4 v24, s[20:23], s76 offen offset:1024 lds
  buffer_load_dwordx4 v25, s[20:23], s76 offen offset:2048 lds
  buffer_load_dwordx4 v26, s[20:23], s76 offen offset:3072 lds
  s_waitcnt lgkmcnt(15)
  v_mfma_f32_32x32x16_bf16 v[32:47], a[224:227], v[224:227], v[32:47]
  ds_read_b64_tr_b16 a[248:249], v4 offset:13312
  ds_read_b64_tr_b16 a[250:251], v4 offset:13824
  s_waitcnt vmcnt(28)
  ds_read_b64_tr_b16 a[64:65], v27 offset:36864
  ds_read_b64_tr_b16 a[66:67], v27 offset:37888
  ds_read_b64_tr_b16 a[68:69], v28 offset:36864
  ds_read_b64_tr_b16 a[70:71], v28 offset:37888
  v_mfma_f32_32x32x16_bf16 v[48:63], a[228:231], v[224:227], v[48:63]
  ds_read_b64_tr_b16 a[252:253], v5 offset:13312
  ds_read_b64_tr_b16 a[254:255], v5 offset:13824
  ds_read_b64_tr_b16 a[72:73], v27 offset:38912
  ds_read_b64_tr_b16 a[74:75], v27 offset:39936
  ds_read_b64_tr_b16 a[76:77], v28 offset:38912
  ds_read_b64_tr_b16 a[78:79], v28 offset:39936
  s_waitcnt lgkmcnt(14)
  s_waitcnt lgkmcnt(15)
  v_mfma_f32_32x32x16_bf16 v[32:47], a[232:235], v[228:231], v[32:47]
  s_waitcnt vmcnt(24)
  s_barrier
  ds_read_b64_tr_b16 a[224:225], v2 offset:12288
  ds_read_b64_tr_b16 a[226:227], v2 offset:12800
  s_add_u32 m0, s65, 32768
  s_mul_i32 s76, s96, 14
  buffer_load_dwordx4 v23, s[20:23], s76 offen offset:0 lds
  buffer_load_dwordx4 v24, s[20:23], s76 offen offset:1024 lds
  buffer_load_dwordx4 v25, s[20:23], s76 offen offset:2048 lds
  buffer_load_dwordx4 v26, s[20:23], s76 offen offset:3072 lds
  ds_read_b64_tr_b16 a[164:165], v27 offset:12288
  ds_read_b64_tr_b16 a[166:167], v28 offset:12288
  v_mfma_f32_32x32x16_bf16 v[48:63], a[236:239], v[228:231], v[48:63]
  ds_read_b64_tr_b16 a[228:229], v3 offset:12288
  s_add_u32 m0, s65, 10240
  ds_read_b64_tr_b16 a[230:231], v3 offset:12800
  buffer_load_dwordx4 v11, s[8:11], s54 offen offset:1024 lds
  s_waitcnt lgkmcnt(6)
  ds_read_b64_tr_b16 a[168:169], v27 offset:1024
  ds_read_b64_tr_b16 a[170:171], v28 offset:1024
  s_waitcnt lgkmcnt(15)
  v_mfma_f32_32x32x16_bf16 v[32:47], a[240:243], v[232:235], v[32:47]
  ds_read_b64_tr_b16 a[232:233], v4 offset:12288
  ds_read_b64_tr_b16 a[234:235], v4 offset:12800
  s_add_u32 m0, s65, 36864
  s_mul_i32 s76, s97, 14
  buffer_load_dwordx4 v23, s[20:23], s76 offen offset:0 lds
  buffer_load_dwordx4 v24, s[20:23], s76 offen offset:1024 lds
  buffer_load_dwordx4 v25, s[20:23], s76 offen offset:2048 lds
  buffer_load_dwordx4 v26, s[20:23], s76 offen offset:3072 lds
  v_mfma_f32_32x32x16_bf16 v[48:63], a[244:247], v[232:235], v[48:63]
  ds_read_b64_tr_b16 a[236:237], v5 offset:12288
  s_add_u32 m0, s65, 10240
  ds_read_b64_tr_b16 a[238:239], v5 offset:12800
  buffer_load_dwordx4 v10, s[8:11], s55 offen lds
  s_mul_i32 s56, s63, s49
  s_waitcnt lgkmcnt(8)
  v_mfma_f32_16x16x32_bf16 a[172:175], a[160:163], a[164:167], a[172:175]
  s_waitcnt lgkmcnt(15)
  v_mfma_f32_32x32x16_bf16 v[32:47], a[248:251], v[236:239], v[32:47]
  ds_read_b64_tr_b16 a[240:241], v2 offset:1024
  ds_read_b64_tr_b16 a[242:243], v2 offset:1536
  s_waitcnt lgkmcnt(6)
  v_mfma_f32_16x16x32_bf16 a[172:175], a[160:163], a[168:171], a[172:175]
  v_mfma_f32_32x32x16_bf16 v[48:63], a[252:255], v[236:239], v[48:63]
  ds_read_b64_tr_b16 a[244:245], v3 offset:1024
  ds_read_b64_tr_b16 a[246:247], v3 offset:1536
  v_lshl_add_u32 v131, s64, 2, v8
  s_waitcnt lgkmcnt(10)
  v_mfma_f32_32x32x16_bf16 v[32:47], a[224:227], v[240:243], v[32:47]
  ds_read_b64_tr_b16 a[248:249], v4 offset:1024
  ds_read_b64_tr_b16 a[250:251], v4 offset:1536
  v_accvgpr_read_b32 v128, a172
  v_cvt_pk_bf16_f32 v129, v128, v128
  v_and_b32 v129, 0xffff0000, v129
  v_sub_f32 v128, v128, v129
  v_cvt_pk_bf16_f32 v128, v129, v128
  v_mfma_f32_32x32x16_bf16 v[48:63], a[228:231], v[240:243], v[48:63]
  ds_read_b64_tr_b16 a[252:253], v5 offset:1024
  ds_read_b64_tr_b16 a[254:255], v5 offset:1536
  s_waitcnt vmcnt(14)
  s_mov_b32 s87, 20000
L_CF_c:
  v_and_b32 v96, 12, v143
  v_cmp_ne_u32 vcc, 1, v29
  s_cbranch_vccz L_CF_ok
  s_sub_u32 s87, s87, 1
  s_cbranch_scc1 L_CF_ok
  buffer_load_dword v29, v96, s[32:35], 0 offen sc1
  s_waitcnt vmcnt(0)
  s_branch L_CF_c
L_CF_ok:
  v_mov_b32 v30, 1
  buffer_store_dword v30, off, s[12:15], s1 sc1
  ds_write_b32 v131, v128 offset:19456
  v_lshlrev_b32 v130, 3, v22
  s_waitcnt lgkmcnt(9)
  v_mfma_f32_32x32x16_bf16 v[32:47], a[232:235], v[244:247], v[32:47]
  s_waitcnt vmcnt(31)
  s_waitcnt lgkmcnt(0)
  s_barrier
  ds_read_b64_tr_b16 a[224:225], v2 offset:0
  ds_read_b64_tr_b16 a[226:227], v2 offset:512
  ds_read_b128 v[132:135], v130 offset:19968
  ds_read_b128 v[128:131], v130 offset:19456
  v_mfma_f32_32x32x16_bf16 v[48:63], a[236:239], v[244:247], v[48:63]
  ds_read_b64_tr_b16 a[228:229], v3 offset:0
  s_add_u32 m0, s65, 12288
  ds_read_b64_tr_b16 a[230:231], v3 offset:512
  buffer_load_dwordx4 v11, s[8:11], s55 offen offset:1024 lds
  s_waitcnt lgkmcnt(11)
  v_mfma_f32_32x32x16_bf16 v[32:47], a[240:243], v[248:251], v[32:47]
  ds_read_b64_tr_b16 a[232:233], v4 offset:0
  ds_read_b64_tr_b16 a[234:235], v4 offset:512
  v_mfma_f32_32x32x16_bf16 v[48:63], a[244:247], v[248:251], v[48:63]
  ds_read_b64_tr_b16 a[236:237], v5 offset:0
  s_add_u32 m0, s65, 12288
  ds_read_b64_tr_b16 a[238:239], v5 offset:512
  buffer_load_dwordx4 v10, s[8:11], s56 offen lds
  v_cmp_gt_u32 vcc, 32, v1
  s_waitcnt lgkmcnt(6)
  s_nop 0
  v_cndmask_b32 v128, v12, v128, vcc
  v_cndmask_b32 v132, v13, v132, vcc
  s_waitcnt lgkmcnt(11)
  v_mfma_f32_32x32x16_bf16 v[32:47], a[248:251], v[252:255], v[32:47]
  ds_read_b64_tr_b16 a[240:241], v2 offset:3072
  ds_read_b64_tr_b16 a[242:243], v2 offset:3584
  v_mfma_f32_32x32x16_bf16 v[32:47], v[128:131], v[16:19], v[32:47]
  v_mfma_f32_32x32x16_bf16 v[48:63], a[252:255], v[252:255], v[48:63]
  ds_read_b64_tr_b16 a[244:245], v3 offset:3072
  ds_read_b64_tr_b16 a[246:247], v3 offset:3584
  v_mfma_f32_32x32x16_bf16 v[48:63], v[132:135], v[16:19], v[48:63]
  s_waitcnt vmcnt(34)
  v_mov_b32 v12, v14
  v_mov_b32 v13, v15
  s_cmp_eq_u32 s69, 7
  s_cbranch_scc1 L_IDLE
  s_mov_b64 s[42:43], s[40:41]
  s_mov_b32 s44, 401408
  s_movk_i32 s46, 896
  s_mov_b32 s49, 14336
  s_mul_i32 s45, s64, 93184
  s_lshl_b32 s75, s69, 7
  s_add_u32 s45, s45, s75
  s_mov_b32 s57, 0
  s_mov_b32 s58, 1
  s_mov_b32 s59, 2
  s_mov_b32 s60, 3
  s_mov_b32 s61, 4
  s_mov_b32 s62, 5
  s_mov_b32 s63, 6
  s_lshl_b32 s74, s67, 6
  s_lshl_b32 s75, s66, 2
  s_add_u32 s74, s74, s75
  s_add_u32 s74, s74, s64
  s_lshl_b32 s74, s74, 7
  s_add_u32 s74, s74, 10354688
  v_mul_f32 v96, v6, v6
  v_lshlrev_b32 v97, 1, v22
  buffer_store_dword v96, v97, s[12:15], s74 offen sc1
  s_lshl_b32 s74, s66, 2
  s_add_u32 s74, s74, s64
  s_mul_i32 s74, s74, 114688
  s_lshl_b32 s75, s67, 12
  s_add_u32 s74, s74, s75
  v_mul_f32_e64 v64, v32, |v32|
  v_mul_f32_e64 v65, v33, |v33|
  v_mul_f32_e64 v66, v34, |v34|
  v_mul_f32_e64 v67, v35, |v35|
  v_mul_f32_e64 v68, v36, |v36|
  v_mul_f32_e64 v69, v37, |v37|
  v_mul_f32_e64 v70, v38, |v38|
  v_mul_f32_e64 v71, v39, |v39|
  v_mul_f32_e64 v72, v40, |v40|
  v_mul_f32_e64 v73, v41, |v41|
  v_mul_f32_e64 v74, v42, |v42|
  v_mul_f32_e64 v75, v43, |v43|
  v_mul_f32_e64 v76, v44, |v44|
  v_mul_f32_e64 v77, v45, |v45|
  v_mul_f32_e64 v78, v46, |v46|
  v_mul_f32_e64 v79, v47, |v47|
  s_waitcnt lgkmcnt(8)
  v_mfma_f32_32x32x16_bf16 v[32:47], a[224:227], v[144:147], 0
  ds_read_b64_tr_b16 a[248:249], v4 offset:3072
  ds_read_b64_tr_b16 a[250:251], v4 offset:3584
  v_mul_f32_e64 v80, v48, |v48|
  v_mul_f32_e64 v81, v49, |v49|
  v_mul_f32_e64 v82, v50, |v50|
  v_mul_f32_e64 v83, v51, |v51|
  v_mul_f32_e64 v84, v52, |v52|
  v_mul_f32_e64 v85, v53, |v53|
  v_mul_f32_e64 v86, v54, |v54|
  v_mul_f32_e64 v87, v55, |v55|
  v_mul_f32_e64 v88, v56, |v56|
  v_mul_f32_e64 v89, v57, |v57|
  v_mul_f32_e64 v90, v58, |v58|
  v_mul_f32_e64 v91, v59, |v59|
  v_mul_f32_e64 v92, v60, |v60|
  v_mul_f32_e64 v93, v61, |v61|
  v_mul_f32_e64 v94, v62, |v62|
  v_mul_f32_e64 v95, v63, |v63|
  v_cvt_pk_bf16_f32 v64, v64, v65
  v_cvt_pk_bf16_f32 v65, v66, v67
  v_pk_max_i16 v64, v64, 0
  v_pk_max_i16 v65, v65, 0
  ds_read_b64_tr_b16 a[164:165], v27 offset:0
  ds_read_b64_tr_b16 a[166:167], v28 offset:0
  v_mfma_f32_32x32x16_bf16 v[48:63], a[228:231], v[144:147], 0
  ds_read_b64_tr_b16 a[252:253], v5 offset:3072
  ds_read_b64_tr_b16 a[254:255], v5 offset:3584
  v_cvt_pk_bf16_f32 v66, v68, v69
  v_cvt_pk_bf16_f32 v67, v70, v71
  v_pk_max_i16 v66, v66, 0
  v_pk_max_i16 v67, v67, 0
  ds_read_b64_tr_b16 a[168:169], v27 offset:3072
  ds_read_b64_tr_b16 a[170:171], v28 offset:3072
  s_waitcnt lgkmcnt(12)
  v_mfma_f32_32x32x16_bf16 v[32:47], a[232:235], v[148:151], v[32:47]
  s_waitcnt vmcnt(32)
  s_barrier
  ds_read_b64_tr_b16 a[224:225], v2 offset:2048
  ds_read_b64_tr_b16 a[226:227], v2 offset:2560
  buffer_store_dwordx4 v[64:67], v8, s[12:15], s74 offen offset:0 sc1
  v_cvt_pk_bf16_f32 v68, v72, v73
  v_cvt_pk_bf16_f32 v69, v74, v75
  v_mfma_f32_32x32x16_bf16 v[48:63], a[236:239], v[148:151], v[48:63]
  ds_read_b64_tr_b16 a[228:229], v3 offset:2048
  s_add_u32 m0, s65, 0
  ds_read_b64_tr_b16 a[230:231], v3 offset:2560
  buffer_load_dwordx4 v11, s[8:11], s56 offen offset:1024 lds
  s_mov_b64 s[8:9], s[42:43]
  s_mov_b32 s10, s44
  s_mul_i32 s50, s57, s49
  v_mad_u32_u24 v10, v20, s46, v21
  v_add_u32 v10, s45, v10
  v_pk_max_i16 v68, v68, 0
  v_pk_max_i16 v69, v69, 0
  v_cvt_pk_bf16_f32 v70, v76, v77
  v_cvt_pk_bf16_f32 v71, v78, v79
  s_waitcnt lgkmcnt(8)
  v_mfma_f32_16x16x32_bf16 a[172:175], a[160:163], a[164:167], 0
  s_waitcnt lgkmcnt(12)
  v_mfma_f32_32x32x16_bf16 v[32:47], a[240:243], v[152:155], v[32:47]
  ds_read_b64_tr_b16 a[232:233], v4 offset:2048
  ds_read_b64_tr_b16 a[234:235], v4 offset:2560
  v_pk_max_i16 v70, v70, 0
  v_pk_max_i16 v71, v71, 0
  buffer_store_dwordx4 v[68:71], v8, s[12:15], s74 offen offset:1024 sc1
  s_waitcnt lgkmcnt(6)
  v_mfma_f32_16x16x32_bf16 a[172:175], a[160:163], a[168:171], a[172:175]
  v_mfma_f32_32x32x16_bf16 v[48:63], a[244:247], v[152:155], v[48:63]
  ds_read_b64_tr_b16 a[236:237], v5 offset:2048
  s_add_u32 m0, s65, 0
  ds_read_b64_tr_b16 a[238:239], v5 offset:2560
  buffer_load_dwordx4 v10, s[8:11], s50 offen lds
  s_lshr_b32 s77, s49, 1
  s_sub_u32 s77, s77, 1024
  v_add_u32 v11, s77, v10
  s_mul_i32 s51, s58, s49
  v_cvt_pk_bf16_f32 v72, v80, v81
  v_cvt_pk_bf16_f32 v73, v82, v83
  v_pk_max_i16 v72, v72, 0
  v_pk_max_i16 v73, v73, 0
  ds_read_b64_tr_b16 a[164:165], v27 offset:2048
  ds_read_b64_tr_b16 a[166:167], v28 offset:2048
  s_waitcnt lgkmcnt(12)
  v_mfma_f32_32x32x16_bf16 v[32:47], a[248:251], v[156:159], v[32:47]
  ds_read_b64_tr_b16 a[240:241], v2 offset:5120
  ds_read_b64_tr_b16 a[242:243], v2 offset:5632
  v_cvt_pk_bf16_f32 v74, v84, v85
  v_cvt_pk_bf16_f32 v75, v86, v87
  v_pk_max_i16 v74, v74, 0
  v_pk_max_i16 v75, v75, 0
  ds_read_b64_tr_b16 a[168:169], v27 offset:5120
  ds_read_b64_tr_b16 a[170:171], v28 offset:5120
  v_mfma_f32_32x32x16_bf16 v[48:63], a[252:255], v[156:159], v[48:63]
  ds_read_b64_tr_b16 a[244:245], v3 offset:5120
  ds_read_b64_tr_b16 a[246:247], v3 offset:5632
  buffer_store_dwordx4 v[72:75], v8, s[12:15], s74 offen offset:2048 sc1
  v_cvt_pk_bf16_f32 v76, v88, v89
  v_cvt_pk_bf16_f32 v77, v90, v91
  s_waitcnt lgkmcnt(12)
  v_mfma_f32_32x32x16_bf16 v[32:47], a[224:227], v[160:163], v[32:47]
  ds_read_b64_tr_b16 a[248:249], v4 offset:5120
  ds_read_b64_tr_b16 a[250:251], v4 offset:5632
  v_pk_max_i16 v76, v76, 0
  v_pk_max_i16 v77, v77, 0
  v_cvt_pk_bf16_f32 v78, v92, v93
  v_cvt_pk_bf16_f32 v79, v94, v95
  s_waitcnt lgkmcnt(8)
  v_mfma_f32_16x16x32_bf16 a[172:175], a[160:163], a[164:167], a[172:175]
  v_mfma_f32_32x32x16_bf16 v[48:63], a[228:231], v[160:163], v[48:63]
  ds_read_b64_tr_b16 a[252:253], v5 offset:5120
  ds_read_b64_tr_b16 a[254:255], v5 offset:5632
  v_pk_max_i16 v78, v78, 0
  v_pk_max_i16 v79, v79, 0
  buffer_store_dwordx4 v[76:79], v8, s[12:15], s74 offen offset:3072 sc1
  s_waitcnt lgkmcnt(6)
  v_mfma_f32_16x16x32_bf16 a[172:175], a[160:163], a[168:171], a[172:175]
  s_waitcnt lgkmcnt(12)
  v_mfma_f32_32x32x16_bf16 v[32:47], a[232:235], v[164:167], v[32:47]
  s_waitcnt vmcnt(36)
  s_barrier
  ds_read_b64_tr_b16 a[224:225], v2 offset:4096
  ds_read_b64_tr_b16 a[226:227], v2 offset:4608
  s_waitcnt vmcnt(31)
  ds_read_b64_tr_b16 a[80:81], v27 offset:20480
  ds_read_b64_tr_b16 a[82:83], v27 offset:21504
  ds_read_b64_tr_b16 a[84:85], v28 offset:20480
  ds_read_b64_tr_b16 a[86:87], v28 offset:21504
  ds_read_b64_tr_b16 a[164:165], v27 offset:4096
  ds_read_b64_tr_b16 a[166:167], v28 offset:4096
  v_mfma_f32_32x32x16_bf16 v[48:63], a[236:239], v[164:167], v[48:63]
  ds_read_b64_tr_b16 a[228:229], v3 offset:4096
  s_add_u32 m0, s65, 2048
  ds_read_b64_tr_b16 a[230:231], v3 offset:4608
  buffer_load_dwordx4 v11, s[8:11], s50 offen offset:1024 lds
  ds_read_b64_tr_b16 a[88:89], v27 offset:22528
  ds_read_b64_tr_b16 a[90:91], v27 offset:23552
  ds_read_b64_tr_b16 a[92:93], v28 offset:22528
  ds_read_b64_tr_b16 a[94:95], v28 offset:23552
  s_waitcnt vmcnt(27)
  ds_read_b64_tr_b16 a[168:169], v27 offset:7168
  ds_read_b64_tr_b16 a[170:171], v28 offset:7168
  s_waitcnt lgkmcnt(15)
  v_mfma_f32_32x32x16_bf16 v[32:47], a[240:243], v[168:171], v[32:47]
  ds_read_b64_tr_b16 a[232:233], v4 offset:4096
  ds_read_b64_tr_b16 a[234:235], v4 offset:4608
  ds_read_b64_tr_b16 a[96:97], v27 offset:24576
  ds_read_b64_tr_b16 a[98:99], v27 offset:25600
  ds_read_b64_tr_b16 a[100:101], v28 offset:24576
  ds_read_b64_tr_b16 a[102:103], v28 offset:25600
  ds_read_b64_tr_b16 a[104:105], v27 offset:26624
  ds_read_b64_tr_b16 a[106:107], v27 offset:27648
  v_mfma_f32_32x32x16_bf16 v[48:63], a[244:247], v[168:171], v[48:63]
  ds_read_b64_tr_b16 a[236:237], v5 offset:4096
  s_add_u32 m0, s65, 2048
  ds_read_b64_tr_b16 a[238:239], v5 offset:4608
  buffer_load_dwordx4 v10, s[8:11], s51 offen lds
  s_mul_i32 s52, s59, s49
  ds_read_b64_tr_b16 a[108:109], v28 offset:26624
  ds_read_b64_tr_b16 a[110:111], v28 offset:27648
  s_waitcnt lgkmcnt(14)
  s_waitcnt lgkmcnt(15)
  v_mfma_f32_16x16x32_bf16 a[172:175], a[160:163], a[164:167], a[172:175]
  s_waitcnt lgkmcnt(15)
  v_mfma_f32_32x32x16_bf16 v[32:47], a[248:251], v[172:175], v[32:47]
  ds_read_b64_tr_b16 a[240:241], v2 offset:7168
  ds_read_b64_tr_b16 a[242:243], v2 offset:7680
  s_add_u32 m0, s65, 20480
  s_mul_i32 s76, s98, 14
  buffer_load_dwordx4 v23, s[20:23], s76 offen offset:0 lds
  buffer_load_dwordx4 v24, s[20:23], s76 offen offset:1024 lds
  buffer_load_dwordx4 v25, s[20:23], s76 offen offset:2048 lds
  buffer_load_dwordx4 v26, s[20:23], s76 offen offset:3072 lds
  s_waitcnt lgkmcnt(14)
  v_mfma_f32_16x16x32_bf16 a[172:175], a[160:163], a[168:171], a[172:175]
  v_mfma_f32_32x32x16_bf16 v[48:63], a[252:255], v[172:175], v[48:63]
  ds_read_b64_tr_b16 a[244:245], v3 offset:7168
  ds_read_b64_tr_b16 a[246:247], v3 offset:7680
  s_waitcnt vmcnt(26)
  ds_read_b64_tr_b16 a[112:113], v27 offset:28672
  ds_read_b64_tr_b16 a[114:115], v27 offset:29696
  ds_read_b64_tr_b16 a[116:117], v28 offset:28672
  ds_read_b64_tr_b16 a[118:119], v28 offset:29696
  s_waitcnt lgkmcnt(15)
  v_mfma_f32_32x32x16_bf16 v[32:47], a[224:227], v[176:179], v[32:47]
  ds_read_b64_tr_b16 a[248:249], v4 offset:7168
  ds_read_b64_tr_b16 a[250:251], v4 offset:7680
  ds_read_b64_tr_b16 a[120:121], v27 offset:30720
  ds_read_b64_tr_b16 a[122:123], v27 offset:31744
  ds_read_b64_tr_b16 a[124:125], v28 offset:30720
  ds_read_b64_tr_b16 a[126:127], v28 offset:31744
  s_waitcnt lgkmcnt(14)
  v_mfma_f32_32x32x16_bf16 v[48:63], a[228:231], v[176:179], v[48:63]
  ds_read_b64_tr_b16 a[252:253], v5 offset:7168
  ds_read_b64_tr_b16 a[254:255], v5 offset:7680
  s_add_u32 m0, s65, 24576
  s_mul_i32 s76, s99, 14
  buffer_load_dwordx4 v23, s[20:23], s76 offen offset:0 lds
  buffer_load_dwordx4 v24, s[20:23], s76 offen offset:1024 lds
  buffer_load_dwordx4 v25, s[20:23], s76 offen offset:2048 lds
  buffer_load_dwordx4 v26, s[20:23], s76 offen offset:3072 lds
  s_waitcnt lgkmcnt(15)
  v_mfma_f32_32x32x16_bf16 v[32:47], a[232:235], v[180:183], v[32:47]
  s_waitcnt vmcnt(40)
  s_barrier
  ds_read_b64_tr_b16 a[224:225], v2 offset:6144
  ds_read_b64_tr_b16 a[226:227], v2 offset:6656
  s_waitcnt vmcnt(26)
  ds_read_b64_tr_b16 a[128:129], v27 offset:32768
  ds_read_b64_tr_b16 a[130:131], v27 offset:33792
  ds_read_b64_tr_b16 a[132:133], v28 offset:32768
  ds_read_b64_tr_b16 a[134:135], v28 offset:33792
  ds_read_b64_tr_b16 a[164:165], v27 offset:6144
  ds_read_b64_tr_b16 a[166:167], v28 offset:6144
  v_mfma_f32_32x32x16_bf16 v[48:63], a[236:239], v[180:183], v[48:63]
  ds_read_b64_tr_b16 a[228:229], v3 offset:6144
  s_add_u32 m0, s65, 4096
  ds_read_b64_tr_b16 a[230:231], v3 offset:6656
  buffer_load_dwordx4 v11, s[8:11], s51 offen offset:1024 lds
  s_waitcnt vmcnt(11)
  v_mov_b32 v30, 1
  buffer_store_dword v30, off, s[12:15], s0 sc1
  ds_read_b64_tr_b16 a[136:137], v27 offset:34816
  ds_read_b64_tr_b16 a[138:139], v27 offset:35840
  ds_read_b64_tr_b16 a[140:141], v28 offset:34816
  ds_read_b64_tr_b16 a[142:143], v28 offset:35840
  s_waitcnt lgkmcnt(15)
  ds_read_b64_tr_b16 a[168:169], v27 offset:9216
  ds_read_b64_tr_b16 a[170:171], v28 offset:9216
  s_waitcnt lgkmcnt(15)
  v_mfma_f32_32x32x16_bf16 v[32:47], a[240:243], v[184:187], v[32:47]
  ds_read_b64_tr_b16 a[232:233], v4 offset:6144
  ds_read_b64_tr_b16 a[234:235], v4 offset:6656
  s_add_u32 m0, s65, 28672
  s_mov_b32 s76, 1376256
  buffer_load_dwordx4 v23, s[20:23], s76 offen offset:0 lds
  buffer_load_dwordx4 v24, s[20:23], s76 offen offset:1024 lds
  buffer_load_dwordx4 v25, s[20:23], s76 offen offset:2048 lds
  buffer_load_dwordx4 v26, s[20:23], s76 offen offset:3072 lds
  v_mfma_f32_32x32x16_bf16 v[48:63], a[244:247], v[184:187], v[48:63]
  ds_read_b64_tr_b16 a[236:237], v5 offset:6144
  s_add_u32 m0, s65, 4096
  ds_read_b64_tr_b16 a[238:239], v5 offset:6656
  buffer_load_dwordx4 v10, s[8:11], s52 offen lds
  s_mul_i32 s53, s60, s49
  s_waitcnt vmcnt(28)
  ds_read_b64_tr_b16 a[144:145], v27 offset:36864
  ds_read_b64_tr_b16 a[146:147], v27 offset:37888
  ds_read_b64_tr_b16 a[148:149], v28 offset:36864
  ds_read_b64_tr_b16 a[150:151], v28 offset:37888
  s_waitcnt lgkmcnt(15)
  v_mfma_f32_16x16x32_bf16 a[172:175], a[160:163], a[164:167], a[172:175]
  s_waitcnt lgkmcnt(15)
  v_mfma_f32_32x32x16_bf16 v[32:47], a[248:251], v[188:191], v[32:47]
  ds_read_b64_tr_b16 a[240:241], v2 offset:9216
  ds_read_b64_tr_b16 a[242:243], v2 offset:9728
  ds_read_b64_tr_b16 a[152:153], v27 offset:38912
  ds_read_b64_tr_b16 a[154:155], v27 offset:39936
  ds_read_b64_tr_b16 a[156:157], v28 offset:38912
  ds_read_b64_tr_b16 a[158:159], v28 offset:39936
  s_waitcnt lgkmcnt(15)
  s_waitcnt lgkmcnt(14)
  v_mfma_f32_16x16x32_bf16 a[172:175], a[160:163], a[168:171], a[172:175]
  v_mfma_f32_32x32x16_bf16 v[48:63], a[252:255], v[188:191], v[48:63]
  ds_read_b64_tr_b16 a[244:245], v3 offset:9216
  ds_read_b64_tr_b16 a[246:247], v3 offset:9728
  s_add_u32 m0, s65, 32768
  s_mov_b32 s76, 1490944
  buffer_load_dwordx4 v23, s[20:23], s76 offen offset:0 lds
  buffer_load_dwordx4 v24, s[20:23], s76 offen offset:1024 lds
  buffer_load_dwordx4 v25, s[20:23], s76 offen offset:2048 lds
  buffer_load_dwordx4 v26, s[20:23], s76 offen offset:3072 lds
  s_waitcnt lgkmcnt(15)
  v_mfma_f32_32x32x16_bf16 v[32:47], a[224:227], v[192:195], v[32:47]
  ds_read_b64_tr_b16 a[248:249], v4 offset:9216
  ds_read_b64_tr_b16 a[250:251], v4 offset:9728
  v_mfma_f32_32x32x16_bf16 v[48:63], a[228:231], v[192:195], v[48:63]
  ds_read_b64_tr_b16 a[252:253], v5 offset:9216
  ds_read_b64_tr_b16 a[254:255], v5 offset:9728
  s_waitcnt lgkmcnt(15)
  v_mfma_f32_32x32x16_bf16 v[32:47], a[232:235], v[196:199], v[32:47]
  s_waitcnt vmcnt(36)
  s_barrier
  ds_read_b64_tr_b16 a[224:225], v2 offset:8192
  ds_read_b64_tr_b16 a[226:227], v2 offset:8704
  ds_read_b64_tr_b16 a[164:165], v27 offset:8192
  ds_read_b64_tr_b16 a[166:167], v28 offset:8192
  v_mfma_f32_32x32x16_bf16 v[48:63], a[236:239], v[196:199], v[48:63]
  ds_read_b64_tr_b16 a[228:229], v3 offset:8192
  s_add_u32 m0, s65, 6144
  ds_read_b64_tr_b16 a[230:231], v3 offset:8704
  buffer_load_dwordx4 v11, s[8:11], s52 offen offset:1024 lds
  ds_read_b64_tr_b16 a[168:169], v27 offset:11264
  ds_read_b64_tr_b16 a[170:171], v28 offset:11264
  s_waitcnt lgkmcnt(12)
  v_mfma_f32_32x32x16_bf16 v[32:47], a[240:243], v[200:203], v[32:47]
  ds_read_b64_tr_b16 a[232:233], v4 offset:8192
  ds_read_b64_tr_b16 a[234:235], v4 offset:8704
  v_mfma_f32_32x32x16_bf16 v[48:63], a[244:247], v[200:203], v[48:63]
  ds_read_b64_tr_b16 a[236:237], v5 offset:8192
  s_add_u32 m0, s65, 6144
  ds_read_b64_tr_b16 a[238:239], v5 offset:8704
  buffer_load_dwordx4 v10, s[8:11], s53 offen lds
  s_mul_i32 s54, s61, s49
  s_waitcnt lgkmcnt(8)
  v_mfma_f32_16x16x32_bf16 a[172:175], a[160:163], a[164:167], a[172:175]
  s_waitcnt lgkmcnt(12)
  v_mfma_f32_32x32x16_bf16 v[32:47], a[248:251], v[204:207], v[32:47]
  ds_read_b64_tr_b16 a[240:241], v2 offset:11264
  ds_read_b64_tr_b16 a[242:243], v2 offset:11776
  s_waitcnt lgkmcnt(6)
  v_mfma_f32_16x16x32_bf16 a[172:175], a[160:163], a[168:171], a[172:175]
  v_mfma_f32_32x32x16_bf16 v[48:63], a[252:255], v[204:207], v[48:63]
  ds_read_b64_tr_b16 a[244:245], v3 offset:11264
  ds_read_b64_tr_b16 a[246:247], v3 offset:11776
  s_waitcnt lgkmcnt(10)
  v_mfma_f32_32x32x16_bf16 v[32:47], a[224:227], v[208:211], v[32:47]
  ds_read_b64_tr_b16 a[248:249], v4 offset:11264
  ds_read_b64_tr_b16 a[250:251], v4 offset:11776
  v_mfma_f32_32x32x16_bf16 v[48:63], a[228:231], v[208:211], v[48:63]
  ds_read_b64_tr_b16 a[252:253], v5 offset:11264
  ds_read_b64_tr_b16 a[254:255], v5 offset:11776
  s_waitcnt lgkmcnt(8)
  v_mfma_f32_32x32x16_bf16 v[32:47], a[232:235], v[212:215], v[32:47]
  s_waitcnt vmcnt(31)
  s_barrier
  ds_read_b64_tr_b16 a[224:225], v2 offset:10240
  ds_read_b64_tr_b16 a[226:227], v2 offset:10752
  ds_read_b64_tr_b16 a[164:165], v27 offset:10240
  ds_read_b64_tr_b16 a[166:167], v28 offset:10240
  v_mfma_f32_32x32x16_bf16 v[48:63], a[236:239], v[212:215], v[48:63]
  ds_read_b64_tr_b16 a[228:229], v3 offset:10240
  s_add_u32 m0, s65, 8192
  ds_read_b64_tr_b16 a[230:231], v3 offset:10752
  buffer_load_dwordx4 v11, s[8:11], s53 offen offset:1024 lds
  ds_read_b64_tr_b16 a[168:169], v27 offset:13312
  ds_read_b64_tr_b16 a[170:171], v28 offset:13312
  s_waitcnt lgkmcnt(12)
  v_mfma_f32_32x32x16_bf16 v[32:47], a[240:243], v[216:219], v[32:47]
  ds_read_b64_tr_b16 a[232:233], v4 offset:10240
  ds_read_b64_tr_b16 a[234:235], v4 offset:10752
  v_mfma_f32_32x32x16_bf16 v[48:63], a[244:247], v[216:219], v[48:63]
  ds_read_b64_tr_b16 a[236:237], v5 offset:10240
  s_add_u32 m0, s65, 8192
  ds_read_b64_tr_b16 a[238:239], v5 offset:10752
  buffer_load_dwordx4 v10, s[8:11], s54 offen lds
  s_mul_i32 s55, s62, s49
  s_waitcnt lgkmcnt(8)
  v_mfma_f32_16x16x32_bf16 a[172:175], a[160:163], a[164:167], a[172:175]
  s_waitcnt lgkmcnt(12)
  v_mfma_f32_32x32x16_bf16 v[32:47], a[248:251], v[220:223], v[32:47]
  ds_read_b64_tr_b16 a[240:241], v2 offset:13312
  ds_read_b64_tr_b16 a[242:243], v2 offset:13824
  s_waitcnt lgkmcnt(6)
  v_mfma_f32_16x16x32_bf16 a[172:175], a[160:163], a[168:171], a[172:175]
  v_mfma_f32_32x32x16_bf16 v[48:63], a[252:255], v[220:223], v[48:63]
  ds_read_b64_tr_b16 a[244:245], v3 offset:13312
  ds_read_b64_tr_b16 a[246:247], v3 offset:13824
  s_waitcnt lgkmcnt(10)
  v_mfma_f32_32x32x16_bf16 v[32:47], a[224:227], v[224:227], v[32:47]
  ds_read_b64_tr_b16 a[248:249], v4 offset:13312
  ds_read_b64_tr_b16 a[250:251], v4 offset:13824
  v_mfma_f32_32x32x16_bf16 v[48:63], a[228:231], v[224:227], v[48:63]
  ds_read_b64_tr_b16 a[252:253], v5 offset:13312
  ds_read_b64_tr_b16 a[254:255], v5 offset:13824
  s_waitcnt lgkmcnt(8)
  v_mfma_f32_32x32x16_bf16 v[32:47], a[232:235], v[228:231], v[32:47]
  s_waitcnt vmcnt(29)
  s_barrier
  ds_read_b64_tr_b16 a[224:225], v2 offset:12288
  ds_read_b64_tr_b16 a[226:227], v2 offset:12800
  ds_read_b64_tr_b16 a[164:165], v27 offset:12288
  ds_read_b64_tr_b16 a[166:167], v28 offset:12288
  v_mfma_f32_32x32x16_bf16 v[48:63], a[236:239], v[228:231], v[48:63]
  ds_read_b64_tr_b16 a[228:229], v3 offset:12288
  s_add_u32 m0, s65, 10240
  ds_read_b64_tr_b16 a[230:231], v3 offset:12800
  buffer_load_dwordx4 v11, s[8:11], s54 offen offset:1024 lds
  ds_read_b64_tr_b16 a[168:169], v27 offset:1024
  ds_read_b64_tr_b16 a[170:171], v28 offset:1024
  s_waitcnt lgkmcnt(12)
  v_mfma_f32_32x32x16_bf16 v[32:47], a[240:243], v[232:235], v[32:47]
  ds_read_b64_tr_b16 a[232:233], v4 offset:12288
  ds_read_b64_tr_b16 a[234:235], v4 offset:12800
  v_mfma_f32_32x32x16_bf16 v[48:63], a[244:247], v[232:235], v[48:63]
  ds_read_b64_tr_b16 a[236:237], v5 offset:12288
  s_add_u32 m0, s65, 10240
  ds_read_b64_tr_b16 a[238:239], v5 offset:12800
  buffer_load_dwordx4 v10, s[8:11], s55 offen lds
  s_mul_i32 s56, s63, s49
  s_waitcnt lgkmcnt(8)
  v_mfma_f32_16x16x32_bf16 a[172:175], a[160:163], a[164:167], a[172:175]
  s_waitcnt lgkmcnt(12)
  v_mfma_f32_32x32x16_bf16 v[32:47], a[248:251], v[236:239], v[32:47]
  ds_read_b64_tr_b16 a[240:241], v2 offset:1024
  ds_read_b64_tr_b16 a[242:243], v2 offset:1536
  s_waitcnt lgkmcnt(6)
  v_mfma_f32_16x16x32_bf16 a[172:175], a[160:163], a[168:171], a[172:175]
  v_mfma_f32_32x32x16_bf16 v[48:63], a[252:255], v[236:239], v[48:63]
  ds_read_b64_tr_b16 a[244:245], v3 offset:1024
  ds_read_b64_tr_b16 a[246:247], v3 offset:1536
  v_lshl_add_u32 v131, s64, 2, v8
  s_waitcnt lgkmcnt(10)
  v_mfma_f32_32x32x16_bf16 v[32:47], a[224:227], v[240:243], v[32:47]
  ds_read_b64_tr_b16 a[248:249], v4 offset:1024
  s_add_u32 m0, s65, 15360
  ds_read_b64_tr_b16 a[250:251], v4 offset:1536
  buffer_load_dwordx4 v11, s[8:11], s56 offen offset:1024 lds
  v_accvgpr_read_b32 v128, a172
  v_cvt_pk_bf16_f32 v129, v128, v128
  v_and_b32 v129, 0xffff0000, v129
  v_sub_f32 v128, v128, v129
  v_cvt_pk_bf16_f32 v128, v129, v128
  v_mfma_f32_32x32x16_bf16 v[48:63], a[228:231], v[240:243], v[48:63]
  ds_read_b64_tr_b16 a[252:253], v5 offset:1024
  ds_read_b64_tr_b16 a[254:255], v5 offset:1536
  ds_write_b32 v131, v128 offset:19456
  v_lshlrev_b32 v130, 3, v22
  s_waitcnt lgkmcnt(9)
  v_mfma_f32_32x32x16_bf16 v[32:47], a[232:235], v[244:247], v[32:47]
  s_waitcnt lgkmcnt(0)
  s_barrier
  ds_read_b128 v[132:135], v130 offset:19968
  ds_read_b128 v[128:131], v130 offset:19456
  s_add_u32 m0, s65, 12288
  v_mfma_f32_32x32x16_bf16 v[48:63], a[236:239], v[244:247], v[48:63]
  buffer_load_dwordx4 v11, s[8:11], s55 offen offset:1024 lds
  s_waitcnt lgkmcnt(7)
  v_mfma_f32_32x32x16_bf16 v[32:47], a[240:243], v[248:251], v[32:47]
  s_add_u32 m0, s65, 12288
  v_mfma_f32_32x32x16_bf16 v[48:63], a[244:247], v[248:251], v[48:63]
  buffer_load_dwordx4 v10, s[8:11], s56 offen lds
  s_lshl_b32 s84, s68, 8
  s_add_u32 s84, s84, 10289152
  buffer_load_dword v29, v143, s[12:15], s84 offen sc1
  v_cmp_gt_u32 vcc, 32, v1
  s_waitcnt lgkmcnt(0)
  s_nop 0
  v_cndmask_b32 v128, v12, v128, vcc
  v_cndmask_b32 v132, v13, v132, vcc
  s_waitcnt lgkmcnt(3)
  v_mfma_f32_32x32x16_bf16 v[32:47], a[248:251], v[252:255], v[32:47]
  v_mfma_f32_32x32x16_bf16 v[32:47], v[128:131], v[16:19], v[32:47]
  v_mfma_f32_32x32x16_bf16 v[48:63], a[252:255], v[252:255], v[48:63]
  v_mfma_f32_32x32x16_bf16 v[48:63], v[132:135], v[16:19], v[48:63]
  s_cmp_lt_u32 s67, 7
  s_cbranch_scc1 L_EQ
  s_lshl_b32 s74, s66, 2
  s_add_u32 s74, s74, s64
  s_mul_i32 s74, s74, 114688
  s_lshl_b32 s75, s86, 12
  s_add_u32 s74, s74, s75
  s_nop 2
  v_mul_f32_e64 v64, v32, |v32|
  v_mul_f32_e64 v65, v33, |v33|
  v_mul_f32_e64 v66, v34, |v34|
  v_mul_f32_e64 v67, v35, |v35|
  v_mul_f32_e64 v68, v36, |v36|
  v_mul_f32_e64 v69, v37, |v37|
  v_mul_f32_e64 v70, v38, |v38|
  v_mul_f32_e64 v71, v39, |v39|
  v_mul_f32_e64 v72, v40, |v40|
  v_mul_f32_e64 v73, v41, |v41|
  v_mul_f32_e64 v74, v42, |v42|
  v_mul_f32_e64 v75, v43, |v43|
  v_mul_f32_e64 v76, v44, |v44|
  v_mul_f32_e64 v77, v45, |v45|
  v_mul_f32_e64 v78, v46, |v46|
  v_mul_f32_e64 v79, v47, |v47|
  v_mul_f32_e64 v80, v48, |v48|
  v_mul_f32_e64 v81, v49, |v49|
  v_mul_f32_e64 v82, v50, |v50|
  v_mul_f32_e64 v83, v51, |v51|
  v_mul_f32_e64 v84, v52, |v52|
  v_mul_f32_e64 v85, v53, |v53|
  v_mul_f32_e64 v86, v54, |v54|
  v_mul_f32_e64 v87, v55, |v55|
  v_mul_f32_e64 v88, v56, |v56|
  v_mul_f32_e64 v89, v57, |v57|
  v_mul_f32_e64 v90, v58, |v58|
  v_mul_f32_e64 v91, v59, |v59|
  v_mul_f32_e64 v92, v60, |v60|
  v_mul_f32_e64 v93, v61, |v61|
  v_mul_f32_e64 v94, v62, |v62|
  v_mul_f32_e64 v95, v63, |v63|
  v_cvt_pk_bf16_f32 v64, v64, v65
  v_cvt_pk_bf16_f32 v65, v66, v67
  v_pk_max_i16 v64, v64, 0
  v_pk_max_i16 v65, v65, 0
  v_cvt_pk_bf16_f32 v66, v68, v69
  v_cvt_pk_bf16_f32 v67, v70, v71
  v_pk_max_i16 v66, v66, 0
  v_pk_max_i16 v67, v67, 0
  buffer_store_dwordx4 v[64:67], v8, s[12:15], s74 offen offset:0 sc1
  v_cvt_pk_bf16_f32 v68, v72, v73
  v_cvt_pk_bf16_f32 v69, v74, v75
  v_pk_max_i16 v68, v68, 0
  v_pk_max_i16 v69, v69, 0
  v_cvt_pk_bf16_f32 v70, v76, v77
  v_cvt_pk_bf16_f32 v71, v78, v79
  v_pk_max_i16 v70, v70, 0
  v_pk_max_i16 v71, v71, 0
  buffer_store_dwordx4 v[68:71], v8, s[12:15], s74 offen offset:1024 sc1
  v_cvt_pk_bf16_f32 v72, v80, v81
  v_cvt_pk_bf16_f32 v73, v82, v83
  v_pk_max_i16 v72, v72, 0
  v_pk_max_i16 v73, v73, 0
  v_cvt_pk_bf16_f32 v74, v84, v85
  v_cvt_pk_bf16_f32 v75, v86, v87
  v_pk_max_i16 v74, v74, 0
  v_pk_max_i16 v75, v75, 0
  buffer_store_dwordx4 v[72:75], v8, s[12:15], s74 offen offset:2048 sc1
  v_cvt_pk_bf16_f32 v76, v88, v89
  v_cvt_pk_bf16_f32 v77, v90, v91
  v_pk_max_i16 v76, v76, 0
  v_pk_max_i16 v77, v77, 0
  v_cvt_pk_bf16_f32 v78, v92, v93
  v_cvt_pk_bf16_f32 v79, v94, v95
  v_pk_max_i16 v78, v78, 0
  v_pk_max_i16 v79, v79, 0
  buffer_store_dwordx4 v[76:79], v8, s[12:15], s74 offen offset:3072 sc1
  s_branch L_EJ
L_EQ:
  s_lshl_b32 s74, s66, 2
  s_add_u32 s74, s74, s64
  s_mul_i32 s74, s74, 28672
  s_lshl_b32 s75, s86, 12
  s_add_u32 s74, s74, s75
  s_add_u32 s74, s74, 7340032
  v_fma_f32 v64, v32, v7, s78
  v_fma_f32 v65, v33, v7, s78
  v_fma_f32 v66, v34, v7, s78
  v_fma_f32 v67, v35, v7, s78
  v_fma_f32 v68, v36, v7, s78
  v_fma_f32 v69, v37, v7, s78
  v_fma_f32 v70, v38, v7, s78
  v_fma_f32 v71, v39, v7, s78
  v_fma_f32 v72, v40, v7, s78
  v_fma_f32 v73, v41, v7, s78
  v_fma_f32 v74, v42, v7, s78
  v_fma_f32 v75, v43, v7, s78
  v_fma_f32 v76, v44, v7, s78
  v_fma_f32 v77, v45, v7, s78
  v_fma_f32 v78, v46, v7, s78
  v_fma_f32 v79, v47, v7, s78
  v_fma_f32 v80, v48, v7, s78
  v_fma_f32 v81, v49, v7, s78
  v_fma_f32 v82, v50, v7, s78
  v_fma_f32 v83, v51, v7, s78
  v_fma_f32 v84, v52, v7, s78
  v_fma_f32 v85, v53, v7, s78
  v_fma_f32 v86, v54, v7, s78
  v_fma_f32 v87, v55, v7, s78
  v_fma_f32 v88, v56, v7, s78
  v_fma_f32 v89, v57, v7, s78
  v_fma_f32 v90, v58, v7, s78
  v_fma_f32 v91, v59, v7, s78
  v_fma_f32 v92, v60, v7, s78
  v_fma_f32 v93, v61, v7, s78
  v_fma_f32 v94, v62, v7, s78
  v_fma_f32 v95, v63, v7, s78
  v_exp_f32 v96, v64 clamp
  v_exp_f32 v97, v65 clamp
  v_max_f32 v64, s78, v64
  v_max_f32 v65, s78, v65
  v_fma_f32 v96, v64, s79, v96
  v_fma_f32 v97, v65, s79, v97
  v_cvt_pk_bf16_f32 v64, v96, v97
  v_exp_f32 v98, v66 clamp
  v_exp_f32 v99, v67 clamp
  v_max_f32 v66, s78, v66
  v_max_f32 v67, s78, v67
  v_fma_f32 v98, v66, s79, v98
  v_fma_f32 v99, v67, s79, v99
  v_cvt_pk_bf16_f32 v65, v98, v99
  v_exp_f32 v96, v68 clamp
  v_exp_f32 v97, v69 clamp
  v_max_f32 v68, s78, v68
  v_max_f32 v69, s78, v69
  v_fma_f32 v96, v68, s79, v96
  v_fma_f32 v97, v69, s79, v97
  v_cvt_pk_bf16_f32 v66, v96, v97
  v_exp_f32 v98, v70 clamp
  v_exp_f32 v99, v71 clamp
  v_max_f32 v70, s78, v70
  v_max_f32 v71, s78, v71
  v_fma_f32 v98, v70, s79, v98
  v_fma_f32 v99, v71, s79, v99
  v_cvt_pk_bf16_f32 v67, v98, v99
  v_permlane32_swap_b32 v64, v66
  s_nop 0
  v_permlane32_swap_b32 v65, v67
  buffer_store_dwordx4 v[64:67], v8, s[12:15], s74 offen offset:0 sc1
  v_exp_f32 v96, v72 clamp
  v_exp_f32 v97, v73 clamp
  v_max_f32 v72, s78, v72
  v_max_f32 v73, s78, v73
  v_fma_f32 v96, v72, s79, v96
  v_fma_f32 v97, v73, s79, v97
  v_cvt_pk_bf16_f32 v68, v96, v97
  v_exp_f32 v98, v74 clamp
  v_exp_f32 v99, v75 clamp
  v_max_f32 v74, s78, v74
  v_max_f32 v75, s78, v75
  v_fma_f32 v98, v74, s79, v98
  v_fma_f32 v99, v75, s79, v99
  v_cvt_pk_bf16_f32 v69, v98, v99
  v_exp_f32 v96, v76 clamp
  v_exp_f32 v97, v77 clamp
  v_max_f32 v76, s78, v76
  v_max_f32 v77, s78, v77
  v_fma_f32 v96, v76, s79, v96
  v_fma_f32 v97, v77, s79, v97
  v_cvt_pk_bf16_f32 v70, v96, v97
  v_exp_f32 v98, v78 clamp
  v_exp_f32 v99, v79 clamp
  v_max_f32 v78, s78, v78
  v_max_f32 v79, s78, v79
  v_fma_f32 v98, v78, s79, v98
  v_fma_f32 v99, v79, s79, v99
  v_cvt_pk_bf16_f32 v71, v98, v99
  v_permlane32_swap_b32 v68, v70
  s_nop 0
  v_permlane32_swap_b32 v69, v71
  buffer_store_dwordx4 v[68:71], v8, s[12:15], s74 offen offset:1024 sc1
  v_exp_f32 v96, v80 clamp
  v_exp_f32 v97, v81 clamp
  v_max_f32 v80, s78, v80
  v_max_f32 v81, s78, v81
  v_fma_f32 v96, v80, s79, v96
  v_fma_f32 v97, v81, s79, v97
  v_cvt_pk_bf16_f32 v72, v96, v97
  v_exp_f32 v98, v82 clamp
  v_exp_f32 v99, v83 clamp
  v_max_f32 v82, s78, v82
  v_max_f32 v83, s78, v83
  v_fma_f32 v98, v82, s79, v98
  v_fma_f32 v99, v83, s79, v99
  v_cvt_pk_bf16_f32 v73, v98, v99
  v_exp_f32 v96, v84 clamp
  v_exp_f32 v97, v85 clamp
  v_max_f32 v84, s78, v84
  v_max_f32 v85, s78, v85
  v_fma_f32 v96, v84, s79, v96
  v_fma_f32 v97, v85, s79, v97
  v_cvt_pk_bf16_f32 v74, v96, v97
  v_exp_f32 v98, v86 clamp
  v_exp_f32 v99, v87 clamp
  v_max_f32 v86, s78, v86
  v_max_f32 v87, s78, v87
  v_fma_f32 v98, v86, s79, v98
  v_fma_f32 v99, v87, s79, v99
  v_cvt_pk_bf16_f32 v75, v98, v99
  v_permlane32_swap_b32 v72, v74
  s_nop 0
  v_permlane32_swap_b32 v73, v75
  buffer_store_dwordx4 v[72:75], v8, s[12:15], s74 offen offset:2048 sc1
  v_exp_f32 v96, v88 clamp
  v_exp_f32 v97, v89 clamp
  v_max_f32 v88, s78, v88
  v_max_f32 v89, s78, v89
  v_fma_f32 v96, v88, s79, v96
  v_fma_f32 v97, v89, s79, v97
  v_cvt_pk_bf16_f32 v76, v96, v97
  v_exp_f32 v98, v90 clamp
  v_exp_f32 v99, v91 clamp
  v_max_f32 v90, s78, v90
  v_max_f32 v91, s78, v91
  v_fma_f32 v98, v90, s79, v98
  v_fma_f32 v99, v91, s79, v99
  v_cvt_pk_bf16_f32 v77, v98, v99
  v_exp_f32 v96, v92 clamp
  v_exp_f32 v97, v93 clamp
  v_max_f32 v92, s78, v92
  v_max_f32 v93, s78, v93
  v_fma_f32 v96, v92, s79, v96
  v_fma_f32 v97, v93, s79, v97
  v_cvt_pk_bf16_f32 v78, v96, v97
  v_exp_f32 v98, v94 clamp
  v_exp_f32 v99, v95 clamp
  v_max_f32 v94, s78, v94
  v_max_f32 v95, s78, v95
  v_fma_f32 v98, v94, s79, v98
  v_fma_f32 v99, v95, s79, v99
  v_cvt_pk_bf16_f32 v79, v98, v99
  v_permlane32_swap_b32 v76, v78
  s_nop 0
  v_permlane32_swap_b32 v77, v79
  buffer_store_dwordx4 v[76:79], v8, s[12:15], s74 offen offset:3072 sc1
L_EJ:
  s_waitcnt vmcnt(4)
  s_mov_b32 s87, 20000
L_PA_c:
  v_cmp_gt_u32 vcc, 1, v29
  s_cbranch_vccz L_PA_ok
  s_sub_u32 s87, s87, 1
  s_cbranch_scc1 L_PA_ok
  buffer_load_dword v29, v143, s[12:15], s84 offen sc1
  s_waitcnt vmcnt(0)
  s_branch L_PA_c
L_PA_ok:
  buffer_load_dwordx4 v[144:147], v136, s[12:15], s88 offen
  buffer_load_dwordx4 v[148:151], v137, s[12:15], s88 offen
  buffer_load_dwordx4 v[152:155], v138, s[12:15], s88 offen
  buffer_load_dwordx4 v[156:159], v139, s[12:15], s88 offen
  buffer_load_dwordx4 v[160:163], v136, s[12:15], s89 offen
  buffer_load_dwordx4 v[164:167], v137, s[12:15], s89 offen
  buffer_load_dwordx4 v[168:171], v138, s[12:15], s89 offen
  buffer_load_dwordx4 v[172:175], v139, s[12:15], s89 offen
  buffer_load_dwordx4 v[176:179], v136, s[12:15], s90 offen
  buffer_load_dwordx4 v[180:183], v137, s[12:15], s90 offen
  buffer_load_dwordx4 v[184:187], v138, s[12:15], s90 offen
  buffer_load_dwordx4 v[188:191], v139, s[12:15], s90 offen
  s_waitcnt vmcnt(41)
  ds_read_b64_tr_b16 a[160:161], v27 offset:20480
  ds_read_b64_tr_b16 a[162:163], v27 offset:21504
  ds_read_b64_tr_b16 a[164:165], v28 offset:20480
  ds_read_b64_tr_b16 a[166:167], v28 offset:21504
  ds_read_b64_tr_b16 a[168:169], v27 offset:22528
  ds_read_b64_tr_b16 a[170:171], v27 offset:23552
  ds_read_b64_tr_b16 a[172:173], v28 offset:22528
  ds_read_b64_tr_b16 a[174:175], v28 offset:23552
  s_waitcnt vmcnt(37)
  ds_read_b64_tr_b16 a[176:177], v27 offset:24576
  ds_read_b64_tr_b16 a[178:179], v27 offset:25600
  ds_read_b64_tr_b16 a[180:181], v28 offset:24576
  ds_read_b64_tr_b16 a[182:183], v28 offset:25600
  ds_read_b64_tr_b16 a[184:185], v27 offset:26624
  ds_read_b64_tr_b16 a[186:187], v27 offset:27648
  ds_read_b64_tr_b16 a[188:189], v28 offset:26624
  ds_read_b64_tr_b16 a[190:191], v28 offset:27648
  s_waitcnt vmcnt(31)
  ds_read_b64_tr_b16 a[192:193], v27 offset:28672
  ds_read_b64_tr_b16 a[194:195], v27 offset:29696
  ds_read_b64_tr_b16 a[196:197], v28 offset:28672
  ds_read_b64_tr_b16 a[198:199], v28 offset:29696
  ds_read_b64_tr_b16 a[200:201], v27 offset:30720
  ds_read_b64_tr_b16 a[202:203], v27 offset:31744
  ds_read_b64_tr_b16 a[204:205], v28 offset:30720
  ds_read_b64_tr_b16 a[206:207], v28 offset:31744
  s_waitcnt vmcnt(26)
  ds_read_b64_tr_b16 a[208:209], v27 offset:32768
  ds_read_b64_tr_b16 a[210:211], v27 offset:33792
  ds_read_b64_tr_b16 a[212:213], v28 offset:32768
  ds_read_b64_tr_b16 a[214:215], v28 offset:33792
  ds_read_b64_tr_b16 a[216:217], v27 offset:34816
  ds_read_b64_tr_b16 a[218:219], v27 offset:35840
  ds_read_b64_tr_b16 a[220:221], v28 offset:34816
  ds_read_b64_tr_b16 a[222:223], v28 offset:35840
  s_lshl_b32 s86, s68, 2
  s_add_u32 s86, s86, s64
  s_mul_i32 s86, s86, 14336
  s_lshl_b32 s76, s69, 7
  s_add_u32 s86, s86, s76
  s_lshl_b32 s85, s64, 7
  s_add_u32 s85, s85, 10305536
  s_mov_b32 s80, -1
  s_mov_b32 s81, 0
  s_mov_b32 s82, 0
  s_mov_b32 s83, -1
  v_and_b32 v22, 63, v143
  v_mov_b32 v23, 0
  v_cmp_eq_u32 vcc, 28, v22
  s_nop 1
  v_cndmask_b32 v23, v23, 3, vcc
  v_cmp_eq_u32 vcc, 60, v22
  s_nop 1
  v_cndmask_b32 v23, v23, 4, vcc
  v_min_u32 v19, 2, v23
  v_sub_u32 v20, 2, v19
  v_lshrrev_b32 v18, 3, v1
  v_lshlrev_b32 v18, 2, v18
  v_and_b32 v21, 7, v1
  v_lshlrev_b32 v21, 4, v21
  s_waitcnt vmcnt(12)
  v_mov_b32 v30, 2
  buffer_store_dword v30, off, s[12:15], s0 sc1
  s_barrier
  buffer_load_dwordx4 v[192:195], v136, s[12:15], s91 offen
  buffer_load_dwordx4 v[196:199], v137, s[12:15], s91 offen
  buffer_load_dwordx4 v[200:203], v138, s[12:15], s91 offen
  buffer_load_dwordx4 v[204:207], v139, s[12:15], s91 offen
  buffer_load_dwordx4 v[208:211], v136, s[12:15], s92 offen
  buffer_load_dwordx4 v[212:215], v137, s[12:15], s92 offen
  buffer_load_dwordx4 v[216:219], v138, s[12:15], s92 offen
  buffer_load_dwordx4 v[220:223], v139, s[12:15], s92 offen
  buffer_load_dwordx4 v[224:227], v136, s[12:15], s93 offen
  buffer_load_dwordx4 v[228:231], v137, s[12:15], s93 offen
  buffer_load_dwordx4 v[232:235], v138, s[12:15], s93 offen
  buffer_load_dwordx4 v[236:239], v139, s[12:15], s93 offen
  buffer_load_dwordx4 v[240:243], v136, s[12:15], s94 offen
  buffer_load_dwordx4 v[244:247], v137, s[12:15], s94 offen
  buffer_load_dwordx4 v[248:251], v138, s[12:15], s94 offen
  buffer_load_dwordx4 v[252:255], v139, s[12:15], s94 offen
  buffer_load_dwordx4 v[96:99], v136, s[12:15], s95 offen
  buffer_load_dwordx4 v[100:103], v137, s[12:15], s95 offen
  buffer_load_dwordx4 v[104:107], v138, s[12:15], s95 offen
  buffer_load_dwordx4 v[108:111], v139, s[12:15], s95 offen
  s_waitcnt lgkmcnt(0)
  s_waitcnt vmcnt(31)
  v_mfma_f32_32x32x16_bf16 v[32:47], a[0:3], v[144:147], 0
  v_mfma_f32_32x32x16_bf16 v[48:63], a[0:3], v[148:151], 0
  v_mfma_f32_32x32x16_bf16 v[64:79], a[4:7], v[144:147], 0
  v_mfma_f32_32x32x16_bf16 v[80:95], a[4:7], v[148:151], 0
  s_waitcnt vmcnt(29)
  v_mfma_f32_32x32x16_bf16 v[32:47], a[8:11], v[152:155], v[32:47]
  v_mfma_f32_32x32x16_bf16 v[48:63], a[8:11], v[156:159], v[48:63]
  v_mfma_f32_32x32x16_bf16 v[64:79], a[12:15], v[152:155], v[64:79]
  v_mfma_f32_32x32x16_bf16 v[80:95], a[12:15], v[156:159], v[80:95]
  s_waitcnt vmcnt(27)
  v_mfma_f32_32x32x16_bf16 v[32:47], a[16:19], v[160:163], v[32:47]
  v_mfma_f32_32x32x16_bf16 v[48:63], a[16:19], v[164:167], v[48:63]
  v_mfma_f32_32x32x16_bf16 v[64:79], a[20:23], v[160:163], v[64:79]
  v_mfma_f32_32x32x16_bf16 v[80:95], a[20:23], v[164:167], v[80:95]
  s_waitcnt vmcnt(25)
  v_mfma_f32_32x32x16_bf16 v[32:47], a[24:27], v[168:171], v[32:47]
  v_mfma_f32_32x32x16_bf16 v[48:63], a[24:27], v[172:175], v[48:63]
  v_mfma_f32_32x32x16_bf16 v[64:79], a[28:31], v[168:171], v[64:79]
  v_mfma_f32_32x32x16_bf16 v[80:95], a[28:31], v[172:175], v[80:95]
  s_waitcnt vmcnt(23)
  v_mfma_f32_32x32x16_bf16 v[32:47], a[32:35], v[176:179], v[32:47]
  v_mfma_f32_32x32x16_bf16 v[48:63], a[32:35], v[180:183], v[48:63]
  v_mfma_f32_32x32x16_bf16 v[64:79], a[36:39], v[176:179], v[64:79]
  v_mfma_f32_32x32x16_bf16 v[80:95], a[36:39], v[180:183], v[80:95]
  s_waitcnt vmcnt(21)
  v_mfma_f32_32x32x16_bf16 v[32:47], a[40:43], v[184:187], v[32:47]
  v_mfma_f32_32x32x16_bf16 v[48:63], a[40:43], v[188:191], v[48:63]
  v_mfma_f32_32x32x16_bf16 v[64:79], a[44:47], v[184:187], v[64:79]
  v_mfma_f32_32x32x16_bf16 v[80:95], a[44:47], v[188:191], v[80:95]
  s_waitcnt vmcnt(18)
  v_mfma_f32_32x32x16_bf16 v[32:47], a[48:51], v[192:195], v[32:47]
  v_mfma_f32_32x32x16_bf16 v[48:63], a[48:51], v[196:199], v[48:63]
  v_mfma_f32_32x32x16_bf16 v[64:79], a[52:55], v[192:195], v[64:79]
  v_mfma_f32_32x32x16_bf16 v[80:95], a[52:55], v[196:199], v[80:95]
  s_waitcnt vmcnt(16)
  v_mfma_f32_32x32x16_bf16 v[32:47], a[56:59], v[200:203], v[32:47]
  v_mfma_f32_32x32x16_bf16 v[48:63], a[56:59], v[204:207], v[48:63]
  v_mfma_f32_32x32x16_bf16 v[64:79], a[60:63], v[200:203], v[64:79]
  v_mfma_f32_32x32x16_bf16 v[80:95], a[60:63], v[204:207], v[80:95]
  s_waitcnt vmcnt(14)
  v_mfma_f32_32x32x16_bf16 v[32:47], a[64:67], v[208:211], v[32:47]
  buffer_load_dword v29, v143, s[12:15], s84 offen sc1
  v_mfma_f32_32x32x16_bf16 v[48:63], a[64:67], v[212:215], v[48:63]
  v_mfma_f32_32x32x16_bf16 v[64:79], a[68:71], v[208:211], v[64:79]
  v_mfma_f32_32x32x16_bf16 v[80:95], a[68:71], v[212:215], v[80:95]
  s_waitcnt vmcnt(13)
  v_mfma_f32_32x32x16_bf16 v[32:47], a[72:75], v[216:219], v[32:47]
  v_mfma_f32_32x32x16_bf16 v[48:63], a[72:75], v[220:223], v[48:63]
  v_mfma_f32_32x32x16_bf16 v[64:79], a[76:79], v[216:219], v[64:79]
  v_mfma_f32_32x32x16_bf16 v[80:95], a[76:79], v[220:223], v[80:95]
  s_waitcnt vmcnt(11)
  v_mfma_f32_32x32x16_bf16 v[32:47], a[80:83], v[224:227], v[32:47]
  v_mfma_f32_32x32x16_bf16 v[48:63], a[80:83], v[228:231], v[48:63]
  v_mfma_f32_32x32x16_bf16 v[64:79], a[84:87], v[224:227], v[64:79]
  v_mfma_f32_32x32x16_bf16 v[80:95], a[84:87], v[228:231], v[80:95]
  s_waitcnt vmcnt(9)
  v_mfma_f32_32x32x16_bf16 v[32:47], a[88:91], v[232:235], v[32:47]
  v_mfma_f32_32x32x16_bf16 v[48:63], a[88:91], v[236:239], v[48:63]
  v_mfma_f32_32x32x16_bf16 v[64:79], a[92:95], v[232:235], v[64:79]
  v_mfma_f32_32x32x16_bf16 v[80:95], a[92:95], v[236:239], v[80:95]
  s_waitcnt vmcnt(0)
  s_mov_b32 s87, 20000
L_PB_c:
  v_cmp_gt_u32 vcc, v20, v29
  s_cbranch_vccz L_PB_ok
  s_sub_u32 s87, s87, 1
  s_cbranch_scc1 L_PB_ok
  buffer_load_dword v29, v143, s[12:15], s84 offen sc1
  s_waitcnt vmcnt(0)
  s_branch L_PB_c
L_PB_ok:
  buffer_load_dwordx4 v[112:115], v136, s[12:15], s96 offen
  buffer_load_dwordx4 v[116:119], v137, s[12:15], s96 offen
  buffer_load_dwordx4 v[120:123], v138, s[12:15], s96 offen
  buffer_load_dwordx4 v[124:127], v139, s[12:15], s96 offen
  buffer_load_dwordx4 v[128:131], v136, s[12:15], s97 offen
  buffer_load_dwordx4 v[132:135], v137, s[12:15], s97 offen
  buffer_load_dwordx4 a[224:227], v138, s[12:15], s97 offen
  buffer_load_dwordx4 a[228:231], v139, s[12:15], s97 offen
  buffer_load_dwordx4 a[232:235], v136, s[12:15], s98 offen
  buffer_load_dwordx4 a[236:239], v137, s[12:15], s98 offen
  buffer_load_dwordx4 a[240:243], v138, s[12:15], s98 offen
  buffer_load_dwordx4 a[244:247], v139, s[12:15], s98 offen
  buffer_load_dwordx4 a[248:251], v136, s[12:15], s99 offen
  buffer_load_dwordx4 a[252:255], v137, s[12:15], s99 offen
  s_mul_i32 s76, s68, 57344
  s_mul_i32 s77, s64, 7168
  s_add_u32 s76, s76, s77
  s_add_u32 s76, s76, 7340032
  s_add_u32 s77, s76, 0
  buffer_load_dwordx4 a[0:3], v8, s[12:15], s77 offen offset:0
  buffer_load_dwordx4 a[4:7], v8, s[12:15], s77 offen offset:1024
  s_add_u32 s77, s76, 28672
  buffer_load_dwordx4 a[8:11], v8, s[12:15], s77 offen offset:0
  buffer_load_dwordx4 a[12:15], v8, s[12:15], s77 offen offset:1024
  s_add_u32 s77, s76, 1536
  buffer_load_dwordx4 a[16:19], v8, s[12:15], s77 offen offset:0
  buffer_load_dwordx4 a[20:23], v8, s[12:15], s77 offen offset:1024
  s_add_u32 s77, s76, 30208
  buffer_load_dwordx4 a[24:27], v8, s[12:15], s77 offen offset:0
  buffer_load_dwordx4 a[28:31], v8, s[12:15], s77 offen offset:1024
  s_add_u32 s77, s76, 3584
  buffer_load_dwordx4 a[32:35], v8, s[12:15], s77 offen offset:0
  buffer_load_dwordx4 a[36:39], v8, s[12:15], s77 offen offset:1024
  s_add_u32 s77, s76, 32256
  buffer_load_dwordx4 a[40:43], v8, s[12:15], s77 offen offset:0
  buffer_load_dwordx4 a[44:47], v8, s[12:15], s77 offen offset:1024
  s_add_u32 s77, s76, 5120
  buffer_load_dwordx4 a[48:51], v8, s[12:15], s77 offen offset:0
  buffer_load_dwordx4 a[52:55], v8, s[12:15], s77 offen offset:1024
  s_add_u32 s77, s76, 33792
  buffer_load_dwordx4 a[56:59], v8, s[12:15], s77 offen offset:0
  buffer_load_dwordx4 a[60:63], v8, s[12:15], s77 offen offset:1024
  s_waitcnt vmcnt(37)
  v_mfma_f32_32x32x16_bf16 v[32:47], a[96:99], v[240:243], v[32:47]
  v_mfma_f32_32x32x16_bf16 v[48:63], a[96:99], v[244:247], v[48:63]
  v_mfma_f32_32x32x16_bf16 v[64:79], a[100:103], v[240:243], v[64:79]
  v_mfma_f32_32x32x16_bf16 v[80:95], a[100:103], v[244:247], v[80:95]
  s_waitcnt vmcnt(35)
  v_mfma_f32_32x32x16_bf16 v[32:47], a[104:107], v[248:251], v[32:47]
  v_mfma_f32_32x32x16_bf16 v[48:63], a[104:107], v[252:255], v[48:63]
  v_mfma_f32_32x32x16_bf16 v[64:79], a[108:111], v[248:251], v[64:79]
  v_mfma_f32_32x32x16_bf16 v[80:95], a[108:111], v[252:255], v[80:95]
  s_waitcnt vmcnt(33)
  v_mfma_f32_32x32x16_bf16 v[32:47], a[112:115], v[96:99], v[32:47]
  v_mfma_f32_32x32x16_bf16 v[48:63], a[112:115], v[100:103], v[48:63]
  v_mfma_f32_32x32x16_bf16 v[64:79], a[116:119], v[96:99], v[64:79]
  v_mfma_f32_32x32x16_bf16 v[80:95], a[116:119], v[100:103], v[80:95]
  s_waitcnt vmcnt(31)
  v_mfma_f32_32x32x16_bf16 v[32:47], a[120:123], v[104:107], v[32:47]
  v_mfma_f32_32x32x16_bf16 v[48:63], a[120:123], v[108:111], v[48:63]
  v_mfma_f32_32x32x16_bf16 v[64:79], a[124:127], v[104:107], v[64:79]
  v_mfma_f32_32x32x16_bf16 v[80:95], a[124:127], v[108:111], v[80:95]
  s_waitcnt vmcnt(28)
  v_mfma_f32_32x32x16_bf16 v[32:47], a[128:131], v[112:115], v[32:47]
  buffer_load_dword v29, v143, s[12:15], s84 offen sc1
  buffer_load_dword v9, v22, s[12:15], s85 offen sc1
  v_mfma_f32_32x32x16_bf16 v[48:63], a[128:131], v[116:119], v[48:63]
  v_mfma_f32_32x32x16_bf16 v[64:79], a[132:135], v[112:115], v[64:79]
  v_mfma_f32_32x32x16_bf16 v[80:95], a[132:135], v[116:119], v[80:95]
  s_waitcnt vmcnt(28)
  v_mfma_f32_32x32x16_bf16 v[32:47], a[136:139], v[120:123], v[32:47]
  v_mfma_f32_32x32x16_bf16 v[48:63], a[136:139], v[124:127], v[48:63]
  v_mfma_f32_32x32x16_bf16 v[64:79], a[140:143], v[120:123], v[64:79]
  v_mfma_f32_32x32x16_bf16 v[80:95], a[140:143], v[124:127], v[80:95]
  s_waitcnt vmcnt(26)
  v_mfma_f32_32x32x16_bf16 v[32:47], a[144:147], v[128:131], v[32:47]
  v_mfma_f32_32x32x16_bf16 v[48:63], a[144:147], v[132:135], v[48:63]
  v_mfma_f32_32x32x16_bf16 v[64:79], a[148:151], v[128:131], v[64:79]
  v_mfma_f32_32x32x16_bf16 v[80:95], a[148:151], v[132:135], v[80:95]
  s_waitcnt vmcnt(24)
  v_mfma_f32_32x32x16_bf16 v[32:47], a[152:155], a[224:227], v[32:47]
  v_mfma_f32_32x32x16_bf16 v[48:63], a[152:155], a[228:231], v[48:63]
  v_mfma_f32_32x32x16_bf16 v[64:79], a[156:159], a[224:227], v[64:79]
  v_mfma_f32_32x32x16_bf16 v[80:95], a[156:159], a[228:231], v[80:95]
  s_waitcnt vmcnt(0)
  s_mov_b32 s87, 20000
L_PI_c:
  v_cmp_gt_u32 vcc, v19, v29
  s_cbranch_vccz L_PI_ok
  s_sub_u32 s87, s87, 1
  s_cbranch_scc1 L_PI_ok
  buffer_load_dword v29, v143, s[12:15], s84 offen sc1
  s_waitcnt vmcnt(0)
  s_branch L_PI_c
L_PI_ok:
  buffer_load_dwordx4 v[144:147], v138, s[12:15], s99 offen
  buffer_load_dwordx4 v[148:151], v139, s[12:15], s99 offen
  s_mov_b32 s75, 98304
  buffer_load_dwordx4 v[152:155], v136, s[12:15], s75 offen
  buffer_load_dwordx4 v[156:159], v137, s[12:15], s75 offen
  s_mov_b32 s87, 20000
L_PK_c:
  v_cmp_ne_u32 vcc, 1, v9
  s_cbranch_vccz L_PK_ok
  s_sub_u32 s87, s87, 1
  s_cbranch_scc1 L_PK_ok
  buffer_load_dword v9, v22, s[12:15], s85 offen sc1
  s_waitcnt vmcnt(0)
  s_branch L_PK_c
L_PK_ok:
  s_lshl_b32 s75, s64, 13
  s_add_u32 s75, s75, 10223616
  buffer_load_dwordx4 a[64:67], v8, s[12:15], s75 offen offset:0
  buffer_load_dwordx4 a[68:71], v8, s[12:15], s75 offen offset:1024
  buffer_load_dwordx4 a[72:75], v8, s[12:15], s75 offen offset:2048
  buffer_load_dwordx4 a[76:79], v8, s[12:15], s75 offen offset:3072
  s_add_u32 s75, s75, 4096
  buffer_load_dwordx4 a[80:83], v8, s[12:15], s75 offen offset:0
  buffer_load_dwordx4 a[84:87], v8, s[12:15], s75 offen offset:1024
  buffer_load_dwordx4 a[88:91], v8, s[12:15], s75 offen offset:2048
  buffer_load_dwordx4 a[92:95], v8, s[12:15], s75 offen offset:3072
  s_waitcnt vmcnt(34)
  v_mfma_f32_32x32x16_bf16 v[32:47], a[160:163], a[232:235], v[32:47]
  v_mfma_f32_32x32x16_bf16 v[48:63], a[160:163], a[236:239], v[48:63]
  v_mfma_f32_32x32x16_bf16 v[64:79], a[164:167], a[232:235], v[64:79]
  v_mfma_f32_32x32x16_bf16 v[80:95], a[164:167], a[236:239], v[80:95]
  s_waitcnt vmcnt(32)
  v_mfma_f32_32x32x16_bf16 v[32:47], a[168:171], a[240:243], v[32:47]
  v_mfma_f32_32x32x16_bf16 v[48:63], a[168:171], a[244:247], v[48:63]
  v_mfma_f32_32x32x16_bf16 v[64:79], a[172:175], a[240:243], v[64:79]
  v_mfma_f32_32x32x16_bf16 v[80:95], a[172:175], a[244:247], v[80:95]
  s_waitcnt vmcnt(30)
  v_mfma_f32_32x32x16_bf16 v[32:47], a[176:179], a[248:251], v[32:47]
  v_mfma_f32_32x32x16_bf16 v[48:63], a[176:179], a[252:255], v[48:63]
  v_mfma_f32_32x32x16_bf16 v[64:79], a[180:183], a[248:251], v[64:79]
  v_mfma_f32_32x32x16_bf16 v[80:95], a[180:183], a[252:255], v[80:95]
  s_waitcnt vmcnt(10)
  v_mfma_f32_32x32x16_bf16 v[32:47], a[184:187], v[144:147], v[32:47]
  v_mfma_f32_32x32x16_bf16 v[48:63], a[184:187], v[148:151], v[48:63]
  v_mfma_f32_32x32x16_bf16 v[64:79], a[188:191], v[144:147], v[64:79]
  v_mfma_f32_32x32x16_bf16 v[80:95], a[188:191], v[148:151], v[80:95]
  s_waitcnt vmcnt(8)
  v_mfma_f32_32x32x16_bf16 v[32:47], a[192:195], v[152:155], v[32:47]
  buffer_load_dword v29, v143, s[12:15], s84 offen sc1
  v_mfma_f32_32x32x16_bf16 v[48:63], a[192:195], v[156:159], v[48:63]
  v_mfma_f32_32x32x16_bf16 v[64:79], a[196:199], v[152:155], v[64:79]
  v_mfma_f32_32x32x16_bf16 v[80:95], a[196:199], v[156:159], v[80:95]
  ds_read_b64_tr_b16 a[96:97], v27 offset:0
  ds_read_b64_tr_b16 a[98:99], v27 offset:3072
  ds_read_b64_tr_b16 a[100:101], v28 offset:0
  ds_read_b64_tr_b16 a[102:103], v28 offset:3072
  ds_read_b64_tr_b16 a[104:105], v27 offset:2048
  ds_read_b64_tr_b16 a[106:107], v27 offset:5120
  ds_read_b64_tr_b16 a[108:109], v28 offset:2048
  ds_read_b64_tr_b16 a[110:111], v28 offset:5120
  s_waitcnt vmcnt(7)
  v_mfma_f32_32x32x16_bf16 v[208:223], a[64:67], a[0:3], 0
  v_mfma_f32_32x32x16_bf16 v[224:239], a[64:67], a[8:11], 0
  v_mfma_f32_32x32x16_bf16 v[208:223], a[68:71], a[4:7], v[208:223]
  v_mfma_f32_32x32x16_bf16 v[224:239], a[68:71], a[12:15], v[224:239]
  s_nop 10
  v_mov_b32 v24, v220
  v_mov_b32 v25, v220
  s_nop 1
  v_permlane32_swap_b32 v24, v25
  v_add_f32 v26, 0x358637bd, v25
  v_rcp_f32 v26, v26
  v_cndmask_b32 v220, v220, 0, s[82:83]
  v_pk_mul_f32 v[208:209], v[208:209], v[26:27] op_sel_hi:[1,0]
  v_pk_mul_f32 v[210:211], v[210:211], v[26:27] op_sel_hi:[1,0]
  v_pk_mul_f32 v[212:213], v[212:213], v[26:27] op_sel_hi:[1,0]
  v_pk_mul_f32 v[214:215], v[214:215], v[26:27] op_sel_hi:[1,0]
  v_pk_mul_f32 v[216:217], v[216:217], v[26:27] op_sel_hi:[1,0]
  v_pk_mul_f32 v[218:219], v[218:219], v[26:27] op_sel_hi:[1,0]
  v_pk_mul_f32 v[220:221], v[220:221], v[26:27] op_sel_hi:[1,0]
  v_pk_mul_f32 v[222:223], v[222:223], v[26:27] op_sel_hi:[1,0]
  v_cvt_pk_bf16_f32 v240, v208, v209
  v_cvt_pk_bf16_f32 v241, v210, v211
  v_cvt_pk_bf16_f32 v242, v212, v213
  v_cvt_pk_bf16_f32 v243, v214, v215
  v_cvt_pk_bf16_f32 v244, v216, v217
  v_cvt_pk_bf16_f32 v245, v218, v219
  v_cvt_pk_bf16_f32 v246, v220, v221
  v_cvt_pk_bf16_f32 v247, v222, v223
  v_mov_b32 v24, v236
  v_mov_b32 v25, v236
  s_nop 1
  v_permlane32_swap_b32 v24, v25
  v_add_f32 v26, 0x358637bd, v25
  v_rcp_f32 v26, v26
  v_cndmask_b32 v236, v236, 0, s[82:83]
  v_pk_mul_f32 v[224:225], v[224:225], v[26:27] op_sel_hi:[1,0]
  v_pk_mul_f32 v[226:227], v[226:227], v[26:27] op_sel_hi:[1,0]
  v_pk_mul_f32 v[228:229], v[228:229], v[26:27] op_sel_hi:[1,0]
  v_pk_mul_f32 v[230:231], v[230:231], v[26:27] op_sel_hi:[1,0]
  v_pk_mul_f32 v[232:233], v[232:233], v[26:27] op_sel_hi:[1,0]
  v_pk_mul_f32 v[234:235], v[234:235], v[26:27] op_sel_hi:[1,0]
  v_pk_mul_f32 v[236:237], v[236:237], v[26:27] op_sel_hi:[1,0]
  v_pk_mul_f32 v[238:239], v[238:239], v[26:27] op_sel_hi:[1,0]
  v_cvt_pk_bf16_f32 v248, v224, v225
  v_cvt_pk_bf16_f32 v249, v226, v227
  v_cvt_pk_bf16_f32 v250, v228, v229
  v_cvt_pk_bf16_f32 v251, v230, v231
  v_cvt_pk_bf16_f32 v252, v232, v233
  v_cvt_pk_bf16_f32 v253, v234, v235
  v_cvt_pk_bf16_f32 v254, v236, v237
  v_cvt_pk_bf16_f32 v255, v238, v239
  s_waitcnt lgkmcnt(0)
  v_mfma_f32_32x32x16_bf16 a[128:143], a[96:99], v[240:243], 0
  v_mfma_f32_32x32x16_bf16 a[144:159], a[96:99], v[248:251], 0
  v_mfma_f32_32x32x16_bf16 a[160:175], a[100:103], v[240:243], 0
  v_mfma_f32_32x32x16_bf16 a[176:191], a[100:103], v[248:251], 0
  v_mfma_f32_32x32x16_bf16 a[128:143], a[104:107], v[244:247], a[128:143]
  v_mfma_f32_32x32x16_bf16 a[144:159], a[104:107], v[252:255], a[144:159]
  v_mfma_f32_32x32x16_bf16 a[160:175], a[108:111], v[244:247], a[160:175]
  v_mfma_f32_32x32x16_bf16 a[176:191], a[108:111], v[252:255], a[176:191]
  ds_read_b64_tr_b16 a[112:113], v27 offset:5120
  ds_read_b64_tr_b16 a[114:115], v27 offset:4096
  ds_read_b64_tr_b16 a[116:117], v28 offset:5120
  ds_read_b64_tr_b16 a[118:119], v28 offset:4096
  ds_read_b64_tr_b16 a[120:121], v27 offset:7168
  ds_read_b64_tr_b16 a[122:123], v27 offset:6144
  ds_read_b64_tr_b16 a[124:125], v28 offset:7168
  ds_read_b64_tr_b16 a[126:127], v28 offset:6144
  s_waitcnt vmcnt(5)
  v_mfma_f32_32x32x16_bf16 v[208:223], a[72:75], a[16:19], 0
  v_mfma_f32_32x32x16_bf16 v[224:239], a[72:75], a[24:27], 0
  v_mfma_f32_32x32x16_bf16 v[208:223], a[76:79], a[20:23], v[208:223]
  v_mfma_f32_32x32x16_bf16 v[224:239], a[76:79], a[28:31], v[224:239]
  s_nop 10
  v_mov_b32 v24, v208
  v_mov_b32 v25, v208
  s_nop 1
  v_permlane32_swap_b32 v24, v25
  v_add_f32 v26, 0x358637bd, v24
  v_rcp_f32 v26, v26
  v_cndmask_b32 v208, v208, 0, s[80:81]
  v_pk_mul_f32 v[208:209], v[208:209], v[26:27] op_sel_hi:[1,0]
  v_pk_mul_f32 v[210:211], v[210:211], v[26:27] op_sel_hi:[1,0]
  v_pk_mul_f32 v[212:213], v[212:213], v[26:27] op_sel_hi:[1,0]
  v_pk_mul_f32 v[214:215], v[214:215], v[26:27] op_sel_hi:[1,0]
  v_pk_mul_f32 v[216:217], v[216:217], v[26:27] op_sel_hi:[1,0]
  v_pk_mul_f32 v[218:219], v[218:219], v[26:27] op_sel_hi:[1,0]
  v_pk_mul_f32 v[220:221], v[220:221], v[26:27] op_sel_hi:[1,0]
  v_pk_mul_f32 v[222:223], v[222:223], v[26:27] op_sel_hi:[1,0]
  v_cvt_pk_bf16_f32 v240, v208, v209
  v_cvt_pk_bf16_f32 v241, v210, v211
  v_cvt_pk_bf16_f32 v242, v212, v213
  v_cvt_pk_bf16_f32 v243, v214, v215
  v_cvt_pk_bf16_f32 v244, v216, v217
  v_cvt_pk_bf16_f32 v245, v218, v219
  v_cvt_pk_bf16_f32 v246, v220, v221
  v_cvt_pk_bf16_f32 v247, v222, v223
  v_mov_b32 v24, v224
  v_mov_b32 v25, v224
  s_nop 1
  v_permlane32_swap_b32 v24, v25
  v_add_f32 v26, 0x358637bd, v24
  v_rcp_f32 v26, v26
  v_cndmask_b32 v224, v224, 0, s[80:81]
  v_pk_mul_f32 v[224:225], v[224:225], v[26:27] op_sel_hi:[1,0]
  v_pk_mul_f32 v[226:227], v[226:227], v[26:27] op_sel_hi:[1,0]
  v_pk_mul_f32 v[228:229], v[228:229], v[26:27] op_sel_hi:[1,0]
  v_pk_mul_f32 v[230:231], v[230:231], v[26:27] op_sel_hi:[1,0]
  v_pk_mul_f32 v[232:233], v[232:233], v[26:27] op_sel_hi:[1,0]
  v_pk_mul_f32 v[234:235], v[234:235], v[26:27] op_sel_hi:[1,0]
  v_pk_mul_f32 v[236:237], v[236:237], v[26:27] op_sel_hi:[1,0]
  v_pk_mul_f32 v[238:239], v[238:239], v[26:27] op_sel_hi:[1,0]
  v_cvt_pk_bf16_f32 v248, v224, v225
  v_cvt_pk_bf16_f32 v249, v226, v227
  v_cvt_pk_bf16_f32 v250, v228, v229
  v_cvt_pk_bf16_f32 v251, v230, v231
  v_cvt_pk_bf16_f32 v252, v232, v233
  v_cvt_pk_bf16_f32 v253, v234, v235
  v_cvt_pk_bf16_f32 v254, v236, v237
  v_cvt_pk_bf16_f32 v255, v238, v239
  s_waitcnt lgkmcnt(0)
  v_mfma_f32_32x32x16_bf16 a[128:143], a[112:115], v[240:243], a[128:143]
  v_mfma_f32_32x32x16_bf16 a[144:159], a[112:115], v[248:251], a[144:159]
  v_mfma_f32_32x32x16_bf16 a[160:175], a[116:119], v[240:243], a[160:175]
  v_mfma_f32_32x32x16_bf16 a[176:191], a[116:119], v[248:251], a[176:191]
  v_mfma_f32_32x32x16_bf16 a[128:143], a[120:123], v[244:247], a[128:143]
  v_mfma_f32_32x32x16_bf16 a[144:159], a[120:123], v[252:255], a[144:159]
  v_mfma_f32_32x32x16_bf16 a[160:175], a[124:127], v[244:247], a[160:175]
  v_mfma_f32_32x32x16_bf16 a[176:191], a[124:127], v[252:255], a[176:191]
  ds_read_b64_tr_b16 a[96:97], v27 offset:9216
  ds_read_b64_tr_b16 a[98:99], v27 offset:8192
  ds_read_b64_tr_b16 a[100:101], v28 offset:9216
  ds_read_b64_tr_b16 a[102:103], v28 offset:8192
  ds_read_b64_tr_b16 a[104:105], v27 offset:11264
  ds_read_b64_tr_b16 a[106:107], v27 offset:10240
  ds_read_b64_tr_b16 a[108:109], v28 offset:11264
  ds_read_b64_tr_b16 a[110:111], v28 offset:10240
  s_waitcnt vmcnt(3)
  v_mfma_f32_32x32x16_bf16 v[208:223], a[80:83], a[32:35], 0
  v_mfma_f32_32x32x16_bf16 v[224:239], a[80:83], a[40:43], 0
  v_mfma_f32_32x32x16_bf16 v[208:223], a[84:87], a[36:39], v[208:223]
  v_mfma_f32_32x32x16_bf16 v[224:239], a[84:87], a[44:47], v[224:239]
  s_waitcnt vmcnt(0)
  s_mov_b32 s87, 20000
L_PL_c:
  v_cmp_gt_u32 vcc, v23, v29
  s_cbranch_vccz L_PL_ok
  s_sub_u32 s87, s87, 1
  s_cbranch_scc1 L_PL_ok
  buffer_load_dword v29, v143, s[12:15], s84 offen sc1
  s_waitcnt vmcnt(0)
  s_branch L_PL_c
L_PL_ok:
  s_mov_b32 s75, 98304
  buffer_load_dwordx4 v[160:163], v138, s[12:15], s75 offen
  buffer_load_dwordx4 v[164:167], v139, s[12:15], s75 offen
  s_mov_b32 s75, 106496
  buffer_load_dwordx4 v[168:171], v136, s[12:15], s75 offen
  buffer_load_dwordx4 v[172:175], v137, s[12:15], s75 offen
  s_mov_b32 s75, 106496
  buffer_load_dwordx4 v[176:179], v138, s[12:15], s75 offen
  buffer_load_dwordx4 v[180:183], v139, s[12:15], s75 offen
  buffer_load_dwordx4 v[100:103], v142, s[4:7], s86 offen
  s_add_u32 s74, s86, 7168
  s_lshl_b32 s76, s69, 7
  buffer_load_dwordx4 v[104:107], v142, s[4:7], s74 offen
  buffer_load_dwordx4 v[96:99], v21, s[28:31], s76 offen
  s_lshl_b32 s76, s67, 7
  s_lshl_b32 s75, s68, 2
  s_add_u32 s76, s76, s75
  s_add_u32 s76, s76, s64
  s_lshl_b32 s76, s76, 6
  s_add_u32 s76, s76, 10354688
  buffer_load_dword v108, v18, s[12:15], s76 offen
  buffer_load_dword v110, v18, s[12:15], s76 offen offset:32
  v_mov_b32 v24, v220
  v_mov_b32 v25, v220
  s_nop 1
  v_permlane32_swap_b32 v24, v25
  v_add_f32 v26, 0x358637bd, v25
  v_rcp_f32 v26, v26
  v_cndmask_b32 v220, v220, 0, s[82:83]
  v_pk_mul_f32 v[208:209], v[208:209], v[26:27] op_sel_hi:[1,0]
  v_pk_mul_f32 v[210:211], v[210:211], v[26:27] op_sel_hi:[1,0]
  v_pk_mul_f32 v[212:213], v[212:213], v[26:27] op_sel_hi:[1,0]
  v_pk_mul_f32 v[214:215], v[214:215], v[26:27] op_sel_hi:[1,0]
  v_pk_mul_f32 v[216:217], v[216:217], v[26:27] op_sel_hi:[1,0]
  v_pk_mul_f32 v[218:219], v[218:219], v[26:27] op_sel_hi:[1,0]
  v_pk_mul_f32 v[220:221], v[220:221], v[26:27] op_sel_hi:[1,0]
  v_pk_mul_f32 v[222:223], v[222:223], v[26:27] op_sel_hi:[1,0]
  v_cvt_pk_bf16_f32 v240, v208, v209
  v_cvt_pk_bf16_f32 v241, v210, v211
  v_cvt_pk_bf16_f32 v242, v212, v213
  v_cvt_pk_bf16_f32 v243, v214, v215
  v_cvt_pk_bf16_f32 v244, v216, v217
  v_cvt_pk_bf16_f32 v245, v218, v219
  v_cvt_pk_bf16_f32 v246, v220, v221
  v_cvt_pk_bf16_f32 v247, v222, v223
  v_mov_b32 v24, v236
  v_mov_b32 v25, v236
  s_nop 1
  v_permlane32_swap_b32 v24, v25
  v_add_f32 v26, 0x358637bd, v25
  v_rcp_f32 v26, v26
  v_cndmask_b32 v236, v236, 0, s[82:83]
  v_pk_mul_f32 v[224:225], v[224:225], v[26:27] op_sel_hi:[1,0]
  v_pk_mul_f32 v[226:227], v[226:227], v[26:27] op_sel_hi:[1,0]
  v_pk_mul_f32 v[228:229], v[228:229], v[26:27] op_sel_hi:[1,0]
  v_pk_mul_f32 v[230:231], v[230:231], v[26:27] op_sel_hi:[1,0]
  v_pk_mul_f32 v[232:233], v[232:233], v[26:27] op_sel_hi:[1,0]
  v_pk_mul_f32 v[234:235], v[234:235], v[26:27] op_sel_hi:[1,0]
  v_pk_mul_f32 v[236:237], v[236:237], v[26:27] op_sel_hi:[1,0]
  v_pk_mul_f32 v[238:239], v[238:239], v[26:27] op_sel_hi:[1,0]
  v_cvt_pk_bf16_f32 v248, v224, v225
  v_cvt_pk_bf16_f32 v249, v226, v227
  v_cvt_pk_bf16_f32 v250, v228, v229
  v_cvt_pk_bf16_f32 v251, v230, v231
  v_cvt_pk_bf16_f32 v252, v232, v233
  v_cvt_pk_bf16_f32 v253, v234, v235
  v_cvt_pk_bf16_f32 v254, v236, v237
  v_cvt_pk_bf16_f32 v255, v238, v239
  s_waitcnt lgkmcnt(0)
  v_mfma_f32_32x32x16_bf16 a[128:143], a[96:99], v[240:243], a[128:143]
  v_mfma_f32_32x32x16_bf16 a[144:159], a[96:99], v[248:251], a[144:159]
  v_mfma_f32_32x32x16_bf16 a[160:175], a[100:103], v[240:243], a[160:175]
  v_mfma_f32_32x32x16_bf16 a[176:191], a[100:103], v[248:251], a[176:191]
  v_mfma_f32_32x32x16_bf16 a[128:143], a[104:107], v[244:247], a[128:143]
  v_mfma_f32_32x32x16_bf16 a[144:159], a[104:107], v[252:255], a[144:159]
  v_mfma_f32_32x32x16_bf16 a[160:175], a[108:111], v[244:247], a[160:175]
  v_mfma_f32_32x32x16_bf16 a[176:191], a[108:111], v[252:255], a[176:191]
  ds_read_b64_tr_b16 a[112:113], v27 offset:10240
  ds_read_b64_tr_b16 a[114:115], v27 offset:13312
  ds_read_b64_tr_b16 a[116:117], v28 offset:10240
  ds_read_b64_tr_b16 a[118:119], v28 offset:13312
  ds_read_b64_tr_b16 a[120:121], v27 offset:12288
  ds_read_b64_tr_b16 a[122:123], v27 offset:16384
  ds_read_b64_tr_b16 a[124:125], v28 offset:12288
  ds_read_b64_tr_b16 a[126:127], v28 offset:16384
  s_waitcnt vmcnt(12)
  v_mfma_f32_32x32x16_bf16 v[208:223], a[88:91], a[48:51], 0
  v_mfma_f32_32x32x16_bf16 v[224:239], a[88:91], a[56:59], 0
  v_mfma_f32_32x32x16_bf16 v[208:223], a[92:95], a[52:55], v[208:223]
  v_mfma_f32_32x32x16_bf16 v[224:239], a[92:95], a[60:63], v[224:239]
  s_nop 10
  v_mov_b32 v24, v208
  v_mov_b32 v25, v208
  s_nop 1
  v_permlane32_swap_b32 v24, v25
  v_add_f32 v26, 0x358637bd, v24
  v_rcp_f32 v26, v26
  v_cndmask_b32 v208, v208, 0, s[80:81]
  v_pk_mul_f32 v[208:209], v[208:209], v[26:27] op_sel_hi:[1,0]
  v_pk_mul_f32 v[210:211], v[210:211], v[26:27] op_sel_hi:[1,0]
  v_pk_mul_f32 v[212:213], v[212:213], v[26:27] op_sel_hi:[1,0]
  v_pk_mul_f32 v[214:215], v[214:215], v[26:27] op_sel_hi:[1,0]
  v_pk_mul_f32 v[216:217], v[216:217], v[26:27] op_sel_hi:[1,0]
  v_pk_mul_f32 v[218:219], v[218:219], v[26:27] op_sel_hi:[1,0]
  v_pk_mul_f32 v[220:221], v[220:221], v[26:27] op_sel_hi:[1,0]
  v_pk_mul_f32 v[222:223], v[222:223], v[26:27] op_sel_hi:[1,0]
  v_cvt_pk_bf16_f32 v240, v208, v209
  v_cvt_pk_bf16_f32 v241, v210, v211
  v_cvt_pk_bf16_f32 v242, v212, v213
  v_cvt_pk_bf16_f32 v243, v214, v215
  v_cvt_pk_bf16_f32 v244, v216, v217
  v_cvt_pk_bf16_f32 v245, v218, v219
  v_cvt_pk_bf16_f32 v246, v220, v221
  v_cvt_pk_bf16_f32 v247, v222, v223
  v_mov_b32 v24, v224
  v_mov_b32 v25, v224
  s_nop 1
  v_permlane32_swap_b32 v24, v25
  v_add_f32 v26, 0x358637bd, v24
  v_rcp_f32 v26, v26
  v_cndmask_b32 v224, v224, 0, s[80:81]
  v_pk_mul_f32 v[224:225], v[224:225], v[26:27] op_sel_hi:[1,0]
  v_pk_mul_f32 v[226:227], v[226:227], v[26:27] op_sel_hi:[1,0]
  v_pk_mul_f32 v[228:229], v[228:229], v[26:27] op_sel_hi:[1,0]
  v_pk_mul_f32 v[230:231], v[230:231], v[26:27] op_sel_hi:[1,0]
  v_pk_mul_f32 v[232:233], v[232:233], v[26:27] op_sel_hi:[1,0]
  v_pk_mul_f32 v[234:235], v[234:235], v[26:27] op_sel_hi:[1,0]
  v_pk_mul_f32 v[236:237], v[236:237], v[26:27] op_sel_hi:[1,0]
  v_pk_mul_f32 v[238:239], v[238:239], v[26:27] op_sel_hi:[1,0]
  v_cvt_pk_bf16_f32 v248, v224, v225
  v_cvt_pk_bf16_f32 v249, v226, v227
  v_cvt_pk_bf16_f32 v250, v228, v229
  v_cvt_pk_bf16_f32 v251, v230, v231
  v_cvt_pk_bf16_f32 v252, v232, v233
  v_cvt_pk_bf16_f32 v253, v234, v235
  v_cvt_pk_bf16_f32 v254, v236, v237
  v_cvt_pk_bf16_f32 v255, v238, v239
  s_waitcnt lgkmcnt(0)
  v_mfma_f32_32x32x16_bf16 a[128:143], a[112:115], v[240:243], a[128:143]
  v_mfma_f32_32x32x16_bf16 a[144:159], a[112:115], v[248:251], a[144:159]
  v_mfma_f32_32x32x16_bf16 a[160:175], a[116:119], v[240:243], a[160:175]
  v_mfma_f32_32x32x16_bf16 a[176:191], a[116:119], v[248:251], a[176:191]
  v_mfma_f32_32x32x16_bf16 a[128:143], a[120:123], v[244:247], a[128:143]
  v_mfma_f32_32x32x16_bf16 a[144:159], a[120:123], v[252:255], a[144:159]
  v_mfma_f32_32x32x16_bf16 a[160:175], a[124:127], v[244:247], a[160:175]
  v_mfma_f32_32x32x16_bf16 a[176:191], a[124:127], v[252:255], a[176:191]
  s_waitcnt vmcnt(9)
  v_mfma_f32_32x32x16_bf16 v[32:47], a[200:203], v[160:163], v[32:47]
  v_mfma_f32_32x32x16_bf16 v[48:63], a[200:203], v[164:167], v[48:63]
  v_mfma_f32_32x32x16_bf16 v[64:79], a[204:207], v[160:163], v[64:79]
  v_mfma_f32_32x32x16_bf16 v[80:95], a[204:207], v[164:167], v[80:95]
  v_xor_b32 v24, 0, v140
  s_nop 2
  ds_write_b128 v24, a[128:131] offset:0
  ds_write_b128 v24, a[144:147] offset:8192
  v_xor_b32 v25, 32, v140
  ds_write_b128 v25, a[132:135] offset:0
  ds_write_b128 v25, a[148:151] offset:8192
  v_xor_b32 v24, 64, v140
  ds_write_b128 v24, a[136:139] offset:0
  ds_write_b128 v24, a[152:155] offset:8192
  v_xor_b32 v25, 96, v140
  ds_write_b128 v25, a[140:143] offset:0
  ds_write_b128 v25, a[156:159] offset:8192
  v_xor_b32 v24, 128, v140
  ds_write_b128 v24, a[160:163] offset:0
  ds_write_b128 v24, a[176:179] offset:8192
  v_xor_b32 v25, 160, v140
  ds_write_b128 v25, a[164:167] offset:0
  ds_write_b128 v25, a[180:183] offset:8192
  v_xor_b32 v24, 192, v140
  ds_write_b128 v24, a[168:171] offset:0
  ds_write_b128 v24, a[184:187] offset:8192
  v_xor_b32 v25, 224, v140
  ds_write_b128 v25, a[172:175] offset:0
  ds_write_b128 v25, a[188:191] offset:8192
  s_waitcnt vmcnt(7)
  v_mfma_f32_32x32x16_bf16 v[32:47], a[208:211], v[168:171], v[32:47]
  v_mfma_f32_32x32x16_bf16 v[48:63], a[208:211], v[172:175], v[48:63]
  v_mfma_f32_32x32x16_bf16 v[64:79], a[212:215], v[168:171], v[64:79]
  v_mfma_f32_32x32x16_bf16 v[80:95], a[212:215], v[172:175], v[80:95]
  s_waitcnt vmcnt(5)
  v_mfma_f32_32x32x16_bf16 v[32:47], a[216:219], v[176:179], v[32:47]
  v_mfma_f32_32x32x16_bf16 v[48:63], a[216:219], v[180:183], v[48:63]
  v_mfma_f32_32x32x16_bf16 v[64:79], a[220:223], v[176:179], v[64:79]
  v_mfma_f32_32x32x16_bf16 v[80:95], a[220:223], v[180:183], v[80:95]
  v_xor_b32 v24, 0, v140
  s_nop 7
  ds_write_b128 v24, v[32:35] offset:16384
  ds_write_b128 v24, v[48:51] offset:24576
  v_xor_b32 v25, 32, v140
  ds_write_b128 v25, v[36:39] offset:16384
  ds_write_b128 v25, v[52:55] offset:24576
  v_xor_b32 v24, 64, v140
  ds_write_b128 v24, v[40:43] offset:16384
  ds_write_b128 v24, v[56:59] offset:24576
  v_xor_b32 v25, 96, v140
  ds_write_b128 v25, v[44:47] offset:16384
  ds_write_b128 v25, v[60:63] offset:24576
  v_xor_b32 v24, 128, v140
  ds_write_b128 v24, v[64:67] offset:16384
  ds_write_b128 v24, v[80:83] offset:24576
  v_xor_b32 v25, 160, v140
  ds_write_b128 v25, v[68:71] offset:16384
  ds_write_b128 v25, v[84:87] offset:24576
  v_xor_b32 v24, 192, v140
  ds_write_b128 v24, v[72:75] offset:16384
  ds_write_b128 v24, v[88:91] offset:24576
  v_xor_b32 v25, 224, v140
  ds_write_b128 v25, v[76:79] offset:16384
  ds_write_b128 v25, v[92:95] offset:24576
  s_waitcnt lgkmcnt(0)
  s_barrier
  v_mov_b32 v27, v141
  v_mov_b32 v20, v142
  v_xor_b32 v24, 16, v141
  v_add_u32 v25, 81920, v141
  v_add_u32 v26, 81920, v24
  ds_read_b128 v[128:131], v27 offset:0
  ds_read_b128 v[132:135], v24 offset:0
  ds_read_b128 v[136:139], v27 offset:40960
  ds_read_b128 v[140:143], v24 offset:40960
  ds_read_b128 v[144:147], v25 offset:0
  ds_read_b128 v[148:151], v26 offset:0
  ds_read_b128 v[152:155], v25 offset:40960
  ds_read_b128 v[156:159], v26 offset:40960
  ds_read_b128 v[160:163], v27 offset:16384
  ds_read_b128 v[164:167], v24 offset:16384
  ds_read_b128 v[168:171], v27 offset:57344
  ds_read_b128 v[172:175], v24 offset:57344
  ds_read_b128 v[176:179], v25 offset:16384
  ds_read_b128 v[180:183], v26 offset:16384
  ds_read_b128 v[184:187], v25 offset:57344
  ds_read_b128 v[188:191], v26 offset:57344
  ds_read_b128 v[192:195], v27 offset:2048
  ds_read_b128 v[196:199], v24 offset:2048
  ds_read_b128 v[200:203], v27 offset:43008
  ds_read_b128 v[204:207], v24 offset:43008
  ds_read_b128 v[208:211], v25 offset:2048
  ds_read_b128 v[212:215], v26 offset:2048
  ds_read_b128 v[216:219], v25 offset:43008
  ds_read_b128 v[220:223], v26 offset:43008
  ds_read_b128 v[224:227], v27 offset:18432
  ds_read_b128 v[228:231], v24 offset:18432
  ds_read_b128 v[232:235], v27 offset:59392
  ds_read_b128 v[236:239], v24 offset:59392
  ds_read_b128 v[240:243], v25 offset:18432
  ds_read_b128 v[244:247], v26 offset:18432
  ds_read_b128 v[248:251], v25 offset:59392
  ds_read_b128 v[252:255], v26 offset:59392
  s_waitcnt vmcnt(0)
  v_lshlrev_b32 v32, 16, v96
  v_and_b32 v33, 0xffff0000, v96
  v_lshlrev_b32 v34, 16, v97
  v_and_b32 v35, 0xffff0000, v97
  v_lshlrev_b32 v36, 16, v98
  v_and_b32 v37, 0xffff0000, v98
  v_lshlrev_b32 v38, 16, v99
  v_and_b32 v39, 0xffff0000, v99
  s_mov_b32 s76, 0xbfb8aa3b
  s_mov_b32 s80, 1.0
  s_mov_b32 s81, 1.0
  s_waitcnt lgkmcnt(15)
  v_pk_add_f32 v[128:129], v[128:129], v[136:137]
  v_pk_add_f32 v[144:145], v[144:145], v[152:153]
  v_pk_add_f32 v[130:131], v[130:131], v[138:139]
  v_pk_add_f32 v[146:147], v[146:147], v[154:155]
  v_pk_add_f32 v[132:133], v[132:133], v[140:141]
  v_pk_add_f32 v[148:149], v[148:149], v[156:157]
  v_pk_add_f32 v[134:135], v[134:135], v[142:143]
  v_pk_add_f32 v[150:151], v[150:151], v[158:159]
  v_pk_add_f32 v[128:129], v[128:129], v[144:145]
  v_pk_add_f32 v[130:131], v[130:131], v[146:147]
  v_pk_add_f32 v[132:133], v[132:133], v[148:149]
  v_pk_add_f32 v[134:135], v[134:135], v[150:151]
  s_waitcnt lgkmcnt(15)
  v_pk_add_f32 v[160:161], v[160:161], v[168:169]
  v_pk_add_f32 v[176:177], v[176:177], v[184:185]
  v_pk_add_f32 v[162:163], v[162:163], v[170:171]
  v_pk_add_f32 v[178:179], v[178:179], v[186:187]
  v_pk_add_f32 v[164:165], v[164:165], v[172:173]
  v_pk_add_f32 v[180:181], v[180:181], v[188:189]
  v_pk_add_f32 v[166:167], v[166:167], v[174:175]
  v_pk_add_f32 v[182:183], v[182:183], v[190:191]
  v_pk_add_f32 v[160:161], v[160:161], v[176:177]
  v_pk_add_f32 v[162:163], v[162:163], v[178:179]
  v_pk_add_f32 v[164:165], v[164:165], v[180:181]
  v_pk_add_f32 v[166:167], v[166:167], v[182:183]
  v_pk_fma_f32 v[160:161], v[160:161], v[108:109], v[32:33] op_sel_hi:[1,0,1]
  v_pk_fma_f32 v[162:163], v[162:163], v[108:109], v[34:35] op_sel_hi:[1,0,1]
  v_pk_fma_f32 v[164:165], v[164:165], v[108:109], v[36:37] op_sel_hi:[1,0,1]
  v_pk_fma_f32 v[166:167], v[166:167], v[108:109], v[38:39] op_sel_hi:[1,0,1]
  v_mul_f32 v48, s76, v160
  v_mul_f32 v49, s76, v161
  v_mul_f32 v50, s76, v162
  v_mul_f32 v51, s76, v163
  v_mul_f32 v52, s76, v164
  v_mul_f32 v53, s76, v165
  v_mul_f32 v54, s76, v166
  v_mul_f32 v55, s76, v167
  v_exp_f32 v48, v48
  v_exp_f32 v49, v49
  v_exp_f32 v50, v50
  v_exp_f32 v51, v51
  v_exp_f32 v52, v52
  v_exp_f32 v53, v53
  v_exp_f32 v54, v54
  v_exp_f32 v55, v55
  v_lshlrev_b32 v40, 16, v100
  v_and_b32 v41, 0xffff0000, v100
  v_lshlrev_b32 v42, 16, v101
  v_and_b32 v43, 0xffff0000, v101
  v_lshlrev_b32 v44, 16, v102
  v_and_b32 v45, 0xffff0000, v102
  v_lshlrev_b32 v46, 16, v103
  v_and_b32 v47, 0xffff0000, v103
  v_pk_add_f32 v[48:49], v[48:49], s[80:81]
  v_pk_add_f32 v[50:51], v[50:51], s[80:81]
  v_pk_add_f32 v[52:53], v[52:53], s[80:81]
  v_pk_add_f32 v[54:55], v[54:55], s[80:81]
  v_rcp_f32 v48, v48
  v_rcp_f32 v49, v49
  v_rcp_f32 v50, v50
  v_rcp_f32 v51, v51
  v_rcp_f32 v52, v52
  v_rcp_f32 v53, v53
  v_rcp_f32 v54, v54
  v_rcp_f32 v55, v55
  v_pk_mul_f32 v[160:161], v[160:161], v[128:129]
  v_pk_mul_f32 v[162:163], v[162:163], v[130:131]
  v_pk_mul_f32 v[164:165], v[164:165], v[132:133]
  v_pk_mul_f32 v[166:167], v[166:167], v[134:135]
  v_pk_fma_f32 v[40:41], v[160:161], v[48:49], v[40:41]
  v_pk_fma_f32 v[42:43], v[162:163], v[50:51], v[42:43]
  v_pk_fma_f32 v[44:45], v[164:165], v[52:53], v[44:45]
  v_pk_fma_f32 v[46:47], v[166:167], v[54:55], v[46:47]
  v_cvt_pk_bf16_f32 v128, v40, v41
  v_cvt_pk_bf16_f32 v129, v42, v43
  v_cvt_pk_bf16_f32 v130, v44, v45
  v_cvt_pk_bf16_f32 v131, v46, v47
  buffer_store_dwordx4 v[128:131], v20, s[24:27], s86 offen
  s_waitcnt lgkmcnt(8)
  v_pk_add_f32 v[192:193], v[192:193], v[200:201]
  v_pk_add_f32 v[208:209], v[208:209], v[216:217]
  v_pk_add_f32 v[194:195], v[194:195], v[202:203]
  v_pk_add_f32 v[210:211], v[210:211], v[218:219]
  v_pk_add_f32 v[196:197], v[196:197], v[204:205]
  v_pk_add_f32 v[212:213], v[212:213], v[220:221]
  v_pk_add_f32 v[198:199], v[198:199], v[206:207]
  v_pk_add_f32 v[214:215], v[214:215], v[222:223]
  v_pk_add_f32 v[192:193], v[192:193], v[208:209]
  v_pk_add_f32 v[194:195], v[194:195], v[210:211]
  v_pk_add_f32 v[196:197], v[196:197], v[212:213]
  v_pk_add_f32 v[198:199], v[198:199], v[214:215]
  s_waitcnt lgkmcnt(0)
  v_pk_add_f32 v[224:225], v[224:225], v[232:233]
  v_pk_add_f32 v[240:241], v[240:241], v[248:249]
  v_pk_add_f32 v[226:227], v[226:227], v[234:235]
  v_pk_add_f32 v[242:243], v[242:243], v[250:251]
  v_pk_add_f32 v[228:229], v[228:229], v[236:237]
  v_pk_add_f32 v[244:245], v[244:245], v[252:253]
  v_pk_add_f32 v[230:231], v[230:231], v[238:239]
  v_pk_add_f32 v[246:247], v[246:247], v[254:255]
  v_pk_add_f32 v[224:225], v[224:225], v[240:241]
  v_pk_add_f32 v[226:227], v[226:227], v[242:243]
  v_pk_add_f32 v[228:229], v[228:229], v[244:245]
  v_pk_add_f32 v[230:231], v[230:231], v[246:247]
  v_pk_fma_f32 v[224:225], v[224:225], v[110:111], v[32:33] op_sel_hi:[1,0,1]
  v_pk_fma_f32 v[226:227], v[226:227], v[110:111], v[34:35] op_sel_hi:[1,0,1]
  v_pk_fma_f32 v[228:229], v[228:229], v[110:111], v[36:37] op_sel_hi:[1,0,1]
  v_pk_fma_f32 v[230:231], v[230:231], v[110:111], v[38:39] op_sel_hi:[1,0,1]
  v_mul_f32 v48, s76, v224
  v_mul_f32 v49, s76, v225
  v_mul_f32 v50, s76, v226
  v_mul_f32 v51, s76, v227
  v_mul_f32 v52, s76, v228
  v_mul_f32 v53, s76, v229
  v_mul_f32 v54, s76, v230
  v_mul_f32 v55, s76, v231
  v_exp_f32 v48, v48
  v_exp_f32 v49, v49
  v_exp_f32 v50, v50
  v_exp_f32 v51, v51
  v_exp_f32 v52, v52
  v_exp_f32 v53, v53
  v_exp_f32 v54, v54
  v_exp_f32 v55, v55
  v_lshlrev_b32 v40, 16, v104
  v_and_b32 v41, 0xffff0000, v104
  v_lshlrev_b32 v42, 16, v105
  v_and_b32 v43, 0xffff0000, v105
  v_lshlrev_b32 v44, 16, v106
  v_and_b32 v45, 0xffff0000, v106
  v_lshlrev_b32 v46, 16, v107
  v_and_b32 v47, 0xffff0000, v107
  v_pk_add_f32 v[48:49], v[48:49], s[80:81]
  v_pk_add_f32 v[50:51], v[50:51], s[80:81]
  v_pk_add_f32 v[52:53], v[52:53], s[80:81]
  v_pk_add_f32 v[54:55], v[54:55], s[80:81]
  v_rcp_f32 v48, v48
  v_rcp_f32 v49, v49
  v_rcp_f32 v50, v50
  v_rcp_f32 v51, v51
  v_rcp_f32 v52, v52
  v_rcp_f32 v53, v53
  v_rcp_f32 v54, v54
  v_rcp_f32 v55, v55
  v_pk_mul_f32 v[224:225], v[224:225], v[192:193]
  v_pk_mul_f32 v[226:227], v[226:227], v[194:195]
  v_pk_mul_f32 v[228:229], v[228:229], v[196:197]
  v_pk_mul_f32 v[230:231], v[230:231], v[198:199]
  v_pk_fma_f32 v[40:41], v[224:225], v[48:49], v[40:41]
  v_pk_fma_f32 v[42:43], v[226:227], v[50:51], v[42:43]
  v_pk_fma_f32 v[44:45], v[228:229], v[52:53], v[44:45]
  v_pk_fma_f32 v[46:47], v[230:231], v[54:55], v[46:47]
  v_cvt_pk_bf16_f32 v192, v40, v41
  v_cvt_pk_bf16_f32 v193, v42, v43
  v_cvt_pk_bf16_f32 v194, v44, v45
  v_cvt_pk_bf16_f32 v195, v46, v47
  buffer_store_dwordx4 v[192:195], v20, s[24:27], s74 offen
L_END:
  s_endpgm
L_IDLE:
  s_mov_b32 s84, 1
  s_mov_b32 s85, s67
  s_cmp_lg_u32 s67, 7
  s_cbranch_scc1 L_ILOOP
  s_add_u32 s77, s86, 2
  s_mov_b64 s[42:43], s[38:39]
  s_cmp_lt_u32 s77, 28
  s_cselect_b32 s44, 1605632, 0
  s_cselect_b32 s47, 3584, 0
  s_lshl_b32 s45, s77, 7
  s_mov_b32 s48, s45
  s_movk_i32 s46, 3584
  s_mov_b32 s49, 229376
  s_lshl_b32 s74, s66, 2
  s_add_u32 s74, s74, s64
  s_mul_i32 s74, s74, 114688
  s_lshl_b32 s75, s85, 12
  s_add_u32 s74, s74, s75
  s_lshl_b32 s76, s66, 2
  s_add_u32 s76, s76, s64
  s_lshl_b32 s76, s76, 7
  s_add_u32 s76, s76, 10297344
  v_and_b32 v9, 63, v143
  v_mul_f32_e64 v64, v32, |v32|
  v_mul_f32_e64 v65, v33, |v33|
  v_mul_f32_e64 v66, v34, |v34|
  v_mul_f32_e64 v67, v35, |v35|
  v_mul_f32_e64 v68, v36, |v36|
  v_mul_f32_e64 v69, v37, |v37|
  v_mul_f32_e64 v70, v38, |v38|
  v_mul_f32_e64 v71, v39, |v39|
  v_mul_f32_e64 v72, v40, |v40|
  v_mul_f32_e64 v73, v41, |v41|
  v_mul_f32_e64 v74, v42, |v42|
  v_mul_f32_e64 v75, v43, |v43|
  v_mul_f32_e64 v76, v44, |v44|
  v_mul_f32_e64 v77, v45, |v45|
  v_mul_f32_e64 v78, v46, |v46|
  v_mul_f32_e64 v79, v47, |v47|
  s_waitcnt lgkmcnt(8)
  v_mfma_f32_32x32x16_bf16 v[32:47], a[224:227], v[144:147], 0
  ds_read_b64_tr_b16 a[248:249], v4 offset:3072
  ds_read_b64_tr_b16 a[250:251], v4 offset:3584
  v_mul_f32_e64 v80, v48, |v48|
  v_mul_f32_e64 v81, v49, |v49|
  v_mul_f32_e64 v82, v50, |v50|
  v_mul_f32_e64 v83, v51, |v51|
  v_mul_f32_e64 v84, v52, |v52|
  v_mul_f32_e64 v85, v53, |v53|
  v_mul_f32_e64 v86, v54, |v54|
  v_mul_f32_e64 v87, v55, |v55|
  v_mul_f32_e64 v88, v56, |v56|
  v_mul_f32_e64 v89, v57, |v57|
  v_mul_f32_e64 v90, v58, |v58|
  v_mul_f32_e64 v91, v59, |v59|
  v_mul_f32_e64 v92, v60, |v60|
  v_mul_f32_e64 v93, v61, |v61|
  v_mul_f32_e64 v94, v62, |v62|
  v_mul_f32_e64 v95, v63, |v63|
  v_cvt_pk_bf16_f32 v64, v64, v65
  v_cvt_pk_bf16_f32 v65, v66, v67
  v_pk_max_i16 v64, v64, 0
  v_pk_max_i16 v65, v65, 0
  ds_read_b64_tr_b16 a[164:165], v27 offset:0
  ds_read_b64_tr_b16 a[166:167], v28 offset:0
  v_mfma_f32_32x32x16_bf16 v[48:63], a[228:231], v[144:147], 0
  ds_read_b64_tr_b16 a[252:253], v5 offset:3072
  ds_read_b64_tr_b16 a[254:255], v5 offset:3584
  v_cvt_pk_bf16_f32 v66, v68, v69
  v_cvt_pk_bf16_f32 v67, v70, v71
  v_pk_max_i16 v66, v66, 0
  v_pk_max_i16 v67, v67, 0
  ds_read_b64_tr_b16 a[168:169], v27 offset:3072
  ds_read_b64_tr_b16 a[170:171], v28 offset:3072
  s_waitcnt lgkmcnt(12)
  v_mfma_f32_32x32x16_bf16 v[32:47], a[232:235], v[148:151], v[32:47]
  s_waitcnt vmcnt(31)
  s_barrier
  ds_read_b64_tr_b16 a[224:225], v2 offset:2048
  ds_read_b64_tr_b16 a[226:227], v2 offset:2560
  buffer_store_dwordx4 v[64:67], v8, s[12:15], s74 offen offset:0 sc1
  v_cvt_pk_bf16_f32 v68, v72, v73
  v_cvt_pk_bf16_f32 v69, v74, v75
  v_mfma_f32_32x32x16_bf16 v[48:63], a[236:239], v[148:151], v[48:63]
  ds_read_b64_tr_b16 a[228:229], v3 offset:2048
  s_add_u32 m0, s65, 0
  ds_read_b64_tr_b16 a[230:231], v3 offset:2560
  buffer_load_dwordx4 v11, s[8:11], s56 offen offset:1024 lds
  s_mov_b64 s[8:9], s[42:43]
  s_mov_b32 s10, s44
  s_mul_i32 s50, s57, s49
  v_mad_u32_u24 v10, v20, s46, v21
  v_add_u32 v10, s45, v10
  v_pk_max_i16 v68, v68, 0
  v_pk_max_i16 v69, v69, 0
  v_cvt_pk_bf16_f32 v70, v76, v77
  v_cvt_pk_bf16_f32 v71, v78, v79
  s_waitcnt lgkmcnt(8)
  v_mfma_f32_16x16x32_bf16 a[172:175], a[160:163], a[164:167], 0
  s_waitcnt lgkmcnt(12)
  v_mfma_f32_32x32x16_bf16 v[32:47], a[240:243], v[152:155], v[32:47]
  ds_read_b64_tr_b16 a[232:233], v4 offset:2048
  ds_read_b64_tr_b16 a[234:235], v4 offset:2560
  v_pk_max_i16 v70, v70, 0
  v_pk_max_i16 v71, v71, 0
  buffer_store_dwordx4 v[68:71], v8, s[12:15], s74 offen offset:1024 sc1
  s_waitcnt lgkmcnt(6)
  v_mfma_f32_16x16x32_bf16 a[172:175], a[160:163], a[168:171], a[172:175]
  v_mfma_f32_32x32x16_bf16 v[48:63], a[244:247], v[152:155], v[48:63]
  ds_read_b64_tr_b16 a[236:237], v5 offset:2048
  s_add_u32 m0, s65, 0
  ds_read_b64_tr_b16 a[238:239], v5 offset:2560
  buffer_load_dwordx4 v10, s[8:11], s50 offen lds
  s_lshr_b32 s77, s49, 1
  s_sub_u32 s77, s77, 1024
  v_add_u32 v11, s77, v10
  s_mul_i32 s51, s58, s49
  v_cvt_pk_bf16_f32 v72, v80, v81
  v_cvt_pk_bf16_f32 v73, v82, v83
  v_pk_max_i16 v72, v72, 0
  v_pk_max_i16 v73, v73, 0
  ds_read_b64_tr_b16 a[164:165], v27 offset:2048
  ds_read_b64_tr_b16 a[166:167], v28 offset:2048
  s_waitcnt lgkmcnt(12)
  v_mfma_f32_32x32x16_bf16 v[32:47], a[248:251], v[156:159], v[32:47]
  ds_read_b64_tr_b16 a[240:241], v2 offset:5120
  ds_read_b64_tr_b16 a[242:243], v2 offset:5632
  v_cvt_pk_bf16_f32 v74, v84, v85
  v_cvt_pk_bf16_f32 v75, v86, v87
  v_pk_max_i16 v74, v74, 0
  v_pk_max_i16 v75, v75, 0
  ds_read_b64_tr_b16 a[168:169], v27 offset:5120
  ds_read_b64_tr_b16 a[170:171], v28 offset:5120
  v_mfma_f32_32x32x16_bf16 v[48:63], a[252:255], v[156:159], v[48:63]
  ds_read_b64_tr_b16 a[244:245], v3 offset:5120
  ds_read_b64_tr_b16 a[246:247], v3 offset:5632
  s_mov_b32 s18, s47
  buffer_load_ushort v14, v22, s[16:19], s48 offen
  buffer_load_ushort v15, v22, s[16:19], s48 offen offset:64
  buffer_store_dwordx4 v[72:75], v8, s[12:15], s74 offen offset:2048 sc1
  v_cvt_pk_bf16_f32 v76, v88, v89
  v_cvt_pk_bf16_f32 v77, v90, v91
  s_waitcnt lgkmcnt(12)
  v_mfma_f32_32x32x16_bf16 v[32:47], a[224:227], v[160:163], v[32:47]
  ds_read_b64_tr_b16 a[248:249], v4 offset:5120
  ds_read_b64_tr_b16 a[250:251], v4 offset:5632
  v_pk_max_i16 v76, v76, 0
  v_pk_max_i16 v77, v77, 0
  v_cvt_pk_bf16_f32 v78, v92, v93
  v_cvt_pk_bf16_f32 v79, v94, v95
  s_waitcnt lgkmcnt(8)
  v_mfma_f32_16x16x32_bf16 a[172:175], a[160:163], a[164:167], a[172:175]
  v_mfma_f32_32x32x16_bf16 v[48:63], a[228:231], v[160:163], v[48:63]
  ds_read_b64_tr_b16 a[252:253], v5 offset:5120
  ds_read_b64_tr_b16 a[254:255], v5 offset:5632
  v_pk_max_i16 v78, v78, 0
  v_pk_max_i16 v79, v79, 0
  buffer_store_dwordx4 v[76:79], v8, s[12:15], s74 offen offset:3072 sc1
  s_waitcnt lgkmcnt(6)
  v_mfma_f32_16x16x32_bf16 a[172:175], a[160:163], a[168:171], a[172:175]
  s_waitcnt lgkmcnt(12)
  v_mfma_f32_32x32x16_bf16 v[32:47], a[232:235], v[164:167], v[32:47]
  s_waitcnt vmcnt(37)
  s_barrier
  ds_read_b64_tr_b16 a[224:225], v2 offset:4096
  ds_read_b64_tr_b16 a[226:227], v2 offset:4608
  ds_read_b64_tr_b16 a[164:165], v27 offset:4096
  ds_read_b64_tr_b16 a[166:167], v28 offset:4096
  v_mfma_f32_32x32x16_bf16 v[48:63], a[236:239], v[164:167], v[48:63]
  ds_read_b64_tr_b16 a[228:229], v3 offset:4096
  s_add_u32 m0, s65, 2048
  ds_read_b64_tr_b16 a[230:231], v3 offset:4608
  buffer_load_dwordx4 v11, s[8:11], s50 offen offset:1024 lds
  ds_read_b64_tr_b16 a[168:169], v27 offset:7168
  ds_read_b64_tr_b16 a[170:171], v28 offset:7168
  s_waitcnt lgkmcnt(12)
  v_mfma_f32_32x32x16_bf16 v[32:47], a[240:243], v[168:171], v[32:47]
  ds_read_b64_tr_b16 a[232:233], v4 offset:4096
  ds_read_b64_tr_b16 a[234:235], v4 offset:4608
  v_mfma_f32_32x32x16_bf16 v[48:63], a[244:247], v[168:171], v[48:63]
  ds_read_b64_tr_b16 a[236:237], v5 offset:4096
  s_add_u32 m0, s65, 2048
  ds_read_b64_tr_b16 a[238:239], v5 offset:4608
  buffer_load_dwordx4 v10, s[8:11], s51 offen lds
  s_mul_i32 s52, s59, s49
  s_waitcnt lgkmcnt(8)
  v_mfma_f32_16x16x32_bf16 a[172:175], a[160:163], a[164:167], a[172:175]
  s_waitcnt lgkmcnt(12)
  v_mfma_f32_32x32x16_bf16 v[32:47], a[248:251], v[172:175], v[32:47]
  ds_read_b64_tr_b16 a[240:241], v2 offset:7168
  ds_read_b64_tr_b16 a[242:243], v2 offset:7680
  s_waitcnt lgkmcnt(6)
  v_mfma_f32_16x16x32_bf16 a[172:175], a[160:163], a[168:171], a[172:175]
  v_mfma_f32_32x32x16_bf16 v[48:63], a[252:255], v[172:175], v[48:63]
  ds_read_b64_tr_b16 a[244:245], v3 offset:7168
  ds_read_b64_tr_b16 a[246:247], v3 offset:7680
  s_waitcnt lgkmcnt(10)
  v_mfma_f32_32x32x16_bf16 v[32:47], a[224:227], v[176:179], v[32:47]
  ds_read_b64_tr_b16 a[248:249], v4 offset:7168
  ds_read_b64_tr_b16 a[250:251], v4 offset:7680
  v_mfma_f32_32x32x16_bf16 v[48:63], a[228:231], v[176:179], v[48:63]
  ds_read_b64_tr_b16 a[252:253], v5 offset:7168
  ds_read_b64_tr_b16 a[254:255], v5 offset:7680
  s_waitcnt lgkmcnt(8)
  v_mfma_f32_32x32x16_bf16 v[32:47], a[232:235], v[180:183], v[32:47]
  s_waitcnt vmcnt(33)
  s_barrier
  ds_read_b64_tr_b16 a[224:225], v2 offset:6144
  ds_read_b64_tr_b16 a[226:227], v2 offset:6656
  buffer_load_dword v29, v9, s[12:15], s76 offen sc1
  ds_read_b64_tr_b16 a[164:165], v27 offset:6144
  ds_read_b64_tr_b16 a[166:167], v28 offset:6144
  v_mfma_f32_32x32x16_bf16 v[48:63], a[236:239], v[180:183], v[48:63]
  ds_read_b64_tr_b16 a[228:229], v3 offset:6144
  s_add_u32 m0, s65, 4096
  ds_read_b64_tr_b16 a[230:231], v3 offset:6656
  buffer_load_dwordx4 v11, s[8:11], s51 offen offset:1024 lds
  s_waitcnt vmcnt(4)
  v_mov_b32 v30, s84
  buffer_store_dword v30, off, s[12:15], s0 sc1
  ds_read_b64_tr_b16 a[168:169], v27 offset:9216
  ds_read_b64_tr_b16 a[170:171], v28 offset:9216
  s_waitcnt lgkmcnt(12)
  v_mfma_f32_32x32x16_bf16 v[32:47], a[240:243], v[184:187], v[32:47]
  ds_read_b64_tr_b16 a[232:233], v4 offset:6144
  ds_read_b64_tr_b16 a[234:235], v4 offset:6656
  v_mfma_f32_32x32x16_bf16 v[48:63], a[244:247], v[184:187], v[48:63]
  ds_read_b64_tr_b16 a[236:237], v5 offset:6144
  s_add_u32 m0, s65, 4096
  ds_read_b64_tr_b16 a[238:239], v5 offset:6656
  buffer_load_dwordx4 v10, s[8:11], s52 offen lds
  s_mul_i32 s53, s60, s49
  s_waitcnt lgkmcnt(8)
  v_mfma_f32_16x16x32_bf16 a[172:175], a[160:163], a[164:167], a[172:175]
  s_waitcnt lgkmcnt(12)
  v_mfma_f32_32x32x16_bf16 v[32:47], a[248:251], v[188:191], v[32:47]
  ds_read_b64_tr_b16 a[240:241], v2 offset:9216
  ds_read_b64_tr_b16 a[242:243], v2 offset:9728
  s_waitcnt lgkmcnt(6)
  v_mfma_f32_16x16x32_bf16 a[172:175], a[160:163], a[168:171], a[172:175]
  v_mfma_f32_32x32x16_bf16 v[48:63], a[252:255], v[188:191], v[48:63]
  ds_read_b64_tr_b16 a[244:245], v3 offset:9216
  ds_read_b64_tr_b16 a[246:247], v3 offset:9728
  s_waitcnt lgkmcnt(10)
  v_mfma_f32_32x32x16_bf16 v[32:47], a[224:227], v[192:195], v[32:47]
  ds_read_b64_tr_b16 a[248:249], v4 offset:9216
  ds_read_b64_tr_b16 a[250:251], v4 offset:9728
  s_waitcnt vmcnt(3)
  s_mov_b32 s87, 20000
L_RK_c:
  v_cmp_ne_u32 vcc, 1, v29
  s_cbranch_vccz L_RK_ok
  s_sub_u32 s87, s87, 1
  s_cbranch_scc1 L_RK_ok
  buffer_load_dword v29, v9, s[12:15], s76 offen sc1
  s_waitcnt vmcnt(0)
  s_branch L_RK_c
L_RK_ok:
  s_lshl_b32 s76, s66, 16
  s_lshl_b32 s75, s64, 10
  s_add_u32 s76, s76, s75
  s_add_u32 s76, s76, 9175040
  v_mfma_f32_32x32x16_bf16 v[48:63], a[228:231], v[192:195], v[48:63]
  ds_read_b64_tr_b16 a[252:253], v5 offset:9216
  ds_read_b64_tr_b16 a[254:255], v5 offset:9728
  buffer_load_dwordx4 v[96:99], v8, s[12:15], s76 offen
  s_add_u32 s76, s76, 4096
  buffer_load_dwordx4 v[100:103], v8, s[12:15], s76 offen
  s_add_u32 s76, s76, 4096
  buffer_load_dwordx4 v[104:107], v8, s[12:15], s76 offen
  s_add_u32 s76, s76, 4096
  s_waitcnt lgkmcnt(8)
  v_mfma_f32_32x32x16_bf16 v[32:47], a[232:235], v[196:199], v[32:47]
  s_waitcnt vmcnt(25)
  s_barrier
  ds_read_b64_tr_b16 a[224:225], v2 offset:8192
  ds_read_b64_tr_b16 a[226:227], v2 offset:8704
  buffer_load_dwordx4 v[108:111], v8, s[12:15], s76 offen
  s_add_u32 s76, s76, 4096
  buffer_load_dwordx4 v[112:115], v8, s[12:15], s76 offen
  s_add_u32 s76, s76, 4096
  buffer_load_dwordx4 v[116:119], v8, s[12:15], s76 offen
  s_add_u32 s76, s76, 4096
  ds_read_b64_tr_b16 a[164:165], v27 offset:8192
  ds_read_b64_tr_b16 a[166:167], v28 offset:8192
  v_mfma_f32_32x32x16_bf16 v[48:63], a[236:239], v[196:199], v[48:63]
  ds_read_b64_tr_b16 a[228:229], v3 offset:8192
  s_add_u32 m0, s65, 6144
  ds_read_b64_tr_b16 a[230:231], v3 offset:8704
  buffer_load_dwordx4 v11, s[8:11], s52 offen offset:1024 lds
  buffer_load_dwordx4 v[120:123], v8, s[12:15], s76 offen
  s_add_u32 s76, s76, 4096
  buffer_load_dwordx4 v[124:127], v8, s[12:15], s76 offen
  s_add_u32 s76, s76, 4096
  buffer_load_dwordx4 v[64:67], v8, s[12:15], s76 offen
  s_add_u32 s76, s76, 4096
  ds_read_b64_tr_b16 a[168:169], v27 offset:11264
  ds_read_b64_tr_b16 a[170:171], v28 offset:11264
  s_waitcnt lgkmcnt(12)
  v_mfma_f32_32x32x16_bf16 v[32:47], a[240:243], v[200:203], v[32:47]
  ds_read_b64_tr_b16 a[232:233], v4 offset:8192
  ds_read_b64_tr_b16 a[234:235], v4 offset:8704
  buffer_load_dwordx4 v[68:71], v8, s[12:15], s76 offen
  s_add_u32 s76, s76, 4096
  buffer_load_dwordx4 v[72:75], v8, s[12:15], s76 offen
  s_add_u32 s76, s76, 4096
  buffer_load_dwordx4 v[76:79], v8, s[12:15], s76 offen
  s_add_u32 s76, s76, 4096
  v_mfma_f32_32x32x16_bf16 v[48:63], a[244:247], v[200:203], v[48:63]
  ds_read_b64_tr_b16 a[236:237], v5 offset:8192
  s_add_u32 m0, s65, 6144
  ds_read_b64_tr_b16 a[238:239], v5 offset:8704
  buffer_load_dwordx4 v10, s[8:11], s53 offen lds
  s_mul_i32 s54, s61, s49
  buffer_load_dwordx4 v[80:83], v8, s[12:15], s76 offen
  s_add_u32 s76, s76, 4096
  buffer_load_dwordx4 v[84:87], v8, s[12:15], s76 offen
  s_add_u32 s76, s76, 4096
  buffer_load_dwordx4 v[88:91], v8, s[12:15], s76 offen
  s_add_u32 s76, s76, 4096
  s_waitcnt lgkmcnt(8)
  v_mfma_f32_16x16x32_bf16 a[172:175], a[160:163], a[164:167], a[172:175]
  s_waitcnt lgkmcnt(12)
  v_mfma_f32_32x32x16_bf16 v[32:47], a[248:251], v[204:207], v[32:47]
  ds_read_b64_tr_b16 a[240:241], v2 offset:11264
  ds_read_b64_tr_b16 a[242:243], v2 offset:11776
  buffer_load_dwordx4 v[92:95], v8, s[12:15], s76 offen
  s_add_u32 s76, s76, 4096
  s_waitcnt lgkmcnt(6)
  v_mfma_f32_16x16x32_bf16 a[172:175], a[160:163], a[168:171], a[172:175]
  v_mfma_f32_32x32x16_bf16 v[48:63], a[252:255], v[204:207], v[48:63]
  ds_read_b64_tr_b16 a[244:245], v3 offset:11264
  ds_read_b64_tr_b16 a[246:247], v3 offset:11776
  s_and_b32 s75, s66, 1
  s_cmp_eq_u32 s75, 0
  s_cselect_b32 s80, 0x1fffffff, 0xfffffff1
  s_waitcnt lgkmcnt(10)
  v_mfma_f32_32x32x16_bf16 v[32:47], a[224:227], v[208:211], v[32:47]
  ds_read_b64_tr_b16 a[248:249], v4 offset:11264
  ds_read_b64_tr_b16 a[250:251], v4 offset:11776
  s_lshr_b32 s77, s64, 1
  s_lshl_b32 s77, s77, 4
  s_lshr_b32 s80, s80, s77
  v_mfma_f32_32x32x16_bf16 v[48:63], a[228:231], v[208:211], v[48:63]
  ds_read_b64_tr_b16 a[252:253], v5 offset:11264
  ds_read_b64_tr_b16 a[254:255], v5 offset:11776
  s_and_b32 s80, s80, 0xffff
  s_mul_i32 s80, s80, 0x10001
  s_mov_b32 s81, s80
  s_waitcnt lgkmcnt(8)
  v_mfma_f32_32x32x16_bf16 v[32:47], a[232:235], v[212:215], v[32:47]
  s_waitcnt vmcnt(33)
  s_barrier
  ds_read_b64_tr_b16 a[224:225], v2 offset:10240
  ds_read_b64_tr_b16 a[226:227], v2 offset:10752
  s_lshl_b32 s75, s75, 1
  s_and_b32 s77, s64, 1
  s_or_b32 s75, s75, s77
  ds_read_b64_tr_b16 a[164:165], v27 offset:10240
  ds_read_b64_tr_b16 a[166:167], v28 offset:10240
  v_mfma_f32_32x32x16_bf16 v[48:63], a[236:239], v[212:215], v[48:63]
  ds_read_b64_tr_b16 a[228:229], v3 offset:10240
  s_add_u32 m0, s65, 8192
  ds_read_b64_tr_b16 a[230:231], v3 offset:10752
  buffer_load_dwordx4 v11, s[8:11], s53 offen offset:1024 lds
  s_cmp_eq_u32 s75, 2
  s_cselect_b32 s77, 0xffff0000, -1
  s_and_b32 s80, s80, s77
  ds_read_b64_tr_b16 a[168:169], v27 offset:13312
  ds_read_b64_tr_b16 a[170:171], v28 offset:13312
  s_waitcnt lgkmcnt(12)
  v_mfma_f32_32x32x16_bf16 v[32:47], a[240:243], v[216:219], v[32:47]
  ds_read_b64_tr_b16 a[232:233], v4 offset:10240
  ds_read_b64_tr_b16 a[234:235], v4 offset:10752
  s_cmp_eq_u32 s75, 1
  s_cselect_b32 s77, 0xffff, -1
  s_and_b32 s81, s81, s77
  v_mfma_f32_32x32x16_bf16 v[48:63], a[244:247], v[216:219], v[48:63]
  ds_read_b64_tr_b16 a[236:237], v5 offset:10240
  s_add_u32 m0, s65, 8192
  ds_read_b64_tr_b16 a[238:239], v5 offset:10752
  buffer_load_dwordx4 v10, s[8:11], s54 offen lds
  s_mul_i32 s55, s62, s49
  v_and_b32 v136, 15, v1
  v_lshrrev_b32 v137, 5, v1
  v_lshl_add_u32 v136, v137, 5, v136
  s_waitcnt lgkmcnt(8)
  v_mfma_f32_16x16x32_bf16 a[172:175], a[160:163], a[164:167], a[172:175]
  s_waitcnt lgkmcnt(12)
  v_mfma_f32_32x32x16_bf16 v[32:47], a[248:251], v[220:223], v[32:47]
  ds_read_b64_tr_b16 a[240:241], v2 offset:13312
  ds_read_b64_tr_b16 a[242:243], v2 offset:13824
  v_lshlrev_b32 v136, 4, v136
  v_bfe_u32 v137, v1, 4, 1
  v_lshl_add_u32 v136, v137, 3, v136
  s_waitcnt lgkmcnt(6)
  v_mfma_f32_16x16x32_bf16 a[172:175], a[160:163], a[168:171], a[172:175]
  v_mfma_f32_32x32x16_bf16 v[48:63], a[252:255], v[220:223], v[48:63]
  ds_read_b64_tr_b16 a[244:245], v3 offset:13312
  ds_read_b64_tr_b16 a[246:247], v3 offset:13824
  s_lshl_b32 s76, s66, 11
  s_and_b32 s75, s64, 1
  s_lshl_b32 s75, s75, 10
  s_add_u32 s76, s76, s75
  s_waitcnt lgkmcnt(10)
  v_mfma_f32_32x32x16_bf16 v[32:47], a[224:227], v[224:227], v[32:47]
  ds_read_b64_tr_b16 a[248:249], v4 offset:13312
  ds_read_b64_tr_b16 a[250:251], v4 offset:13824
  s_lshr_b32 s75, s64, 1
  s_lshl_b32 s75, s75, 8
  s_add_u32 s76, s76, s75
  s_add_u32 s76, s76, 10223616
  s_waitcnt vmcnt(18)
  v_add_f32 v96, v96, v100
  v_add_f32 v97, v97, v101
  v_add_f32 v98, v98, v102
  v_add_f32 v99, v99, v103
  v_mfma_f32_32x32x16_bf16 v[48:63], a[228:231], v[224:227], v[48:63]
  ds_read_b64_tr_b16 a[252:253], v5 offset:13312
  ds_read_b64_tr_b16 a[254:255], v5 offset:13824
  s_waitcnt vmcnt(17)
  v_add_f32 v96, v96, v104
  v_add_f32 v97, v97, v105
  v_add_f32 v98, v98, v106
  v_add_f32 v99, v99, v107
  s_waitcnt vmcnt(16)
  v_add_f32 v96, v96, v108
  v_add_f32 v97, v97, v109
  v_add_f32 v98, v98, v110
  v_add_f32 v99, v99, v111
  s_waitcnt lgkmcnt(8)
  v_mfma_f32_32x32x16_bf16 v[32:47], a[232:235], v[228:231], v[32:47]
  s_waitcnt vmcnt(32)
  s_barrier
  ds_read_b64_tr_b16 a[224:225], v2 offset:12288
  ds_read_b64_tr_b16 a[226:227], v2 offset:12800
  s_waitcnt vmcnt(15)
  v_add_f32 v96, v96, v112
  v_add_f32 v97, v97, v113
  v_add_f32 v98, v98, v114
  v_add_f32 v99, v99, v115
  s_waitcnt vmcnt(14)
  v_add_f32 v96, v96, v116
  v_add_f32 v97, v97, v117
  v_add_f32 v98, v98, v118
  v_add_f32 v99, v99, v119
  ds_read_b64_tr_b16 a[164:165], v27 offset:12288
  ds_read_b64_tr_b16 a[166:167], v28 offset:12288
  v_mfma_f32_32x32x16_bf16 v[48:63], a[236:239], v[228:231], v[48:63]
  ds_read_b64_tr_b16 a[228:229], v3 offset:12288
  s_add_u32 m0, s65, 10240
  ds_read_b64_tr_b16 a[230:231], v3 offset:12800
  buffer_load_dwordx4 v11, s[8:11], s54 offen offset:1024 lds
  s_waitcnt vmcnt(13)
  v_add_f32 v96, v96, v120
  v_add_f32 v97, v97, v121
  v_add_f32 v98, v98, v122
  v_add_f32 v99, v99, v123
  s_waitcnt vmcnt(12)
  v_add_f32 v96, v96, v124
  v_add_f32 v97, v97, v125
  v_add_f32 v98, v98, v126
  v_add_f32 v99, v99, v127
  ds_read_b64_tr_b16 a[168:169], v27 offset:1024
  ds_read_b64_tr_b16 a[170:171], v28 offset:1024
  s_waitcnt lgkmcnt(12)
  v_mfma_f32_32x32x16_bf16 v[32:47], a[240:243], v[232:235], v[32:47]
  ds_read_b64_tr_b16 a[232:233], v4 offset:12288
  ds_read_b64_tr_b16 a[234:235], v4 offset:12800
  s_waitcnt vmcnt(11)
  v_add_f32 v96, v96, v64
  v_add_f32 v97, v97, v65
  v_add_f32 v98, v98, v66
  v_add_f32 v99, v99, v67
  s_waitcnt vmcnt(10)
  v_add_f32 v96, v96, v68
  v_add_f32 v97, v97, v69
  v_add_f32 v98, v98, v70
  v_add_f32 v99, v99, v71
  v_mfma_f32_32x32x16_bf16 v[48:63], a[244:247], v[232:235], v[48:63]
  ds_read_b64_tr_b16 a[236:237], v5 offset:12288
  s_add_u32 m0, s65, 10240
  ds_read_b64_tr_b16 a[238:239], v5 offset:12800
  buffer_load_dwordx4 v10, s[8:11], s55 offen lds
  s_mul_i32 s56, s63, s49
  s_waitcnt vmcnt(10)
  v_add_f32 v96, v96, v72
  v_add_f32 v97, v97, v73
  v_add_f32 v98, v98, v74
  v_add_f32 v99, v99, v75
  s_waitcnt vmcnt(9)
  v_add_f32 v96, v96, v76
  v_add_f32 v97, v97, v77
  v_add_f32 v98, v98, v78
  v_add_f32 v99, v99, v79
  s_waitcnt lgkmcnt(8)
  v_mfma_f32_16x16x32_bf16 a[172:175], a[160:163], a[164:167], a[172:175]
  s_waitcnt lgkmcnt(12)
  v_mfma_f32_32x32x16_bf16 v[32:47], a[248:251], v[236:239], v[32:47]
  ds_read_b64_tr_b16 a[240:241], v2 offset:1024
  ds_read_b64_tr_b16 a[242:243], v2 offset:1536
  s_waitcnt vmcnt(7)
  v_add_f32 v96, v96, v80
  v_add_f32 v97, v97, v81
  v_add_f32 v98, v98, v82
  v_add_f32 v99, v99, v83
  s_waitcnt vmcnt(6)
  v_add_f32 v96, v96, v84
  v_add_f32 v97, v97, v85
  v_add_f32 v98, v98, v86
  v_add_f32 v99, v99, v87
  s_waitcnt lgkmcnt(6)
  v_mfma_f32_16x16x32_bf16 a[172:175], a[160:163], a[168:171], a[172:175]
  v_mfma_f32_32x32x16_bf16 v[48:63], a[252:255], v[236:239], v[48:63]
  ds_read_b64_tr_b16 a[244:245], v3 offset:1024
  ds_read_b64_tr_b16 a[246:247], v3 offset:1536
  s_waitcnt vmcnt(5)
  v_add_f32 v96, v96, v88
  v_add_f32 v97, v97, v89
  v_add_f32 v98, v98, v90
  v_add_f32 v99, v99, v91
  s_waitcnt vmcnt(4)
  v_add_f32 v96, v96, v92
  v_add_f32 v97, v97, v93
  v_add_f32 v98, v98, v94
  v_add_f32 v99, v99, v95
  v_lshl_add_u32 v131, s64, 2, v8
  s_waitcnt lgkmcnt(10)
  v_mfma_f32_32x32x16_bf16 v[32:47], a[224:227], v[240:243], v[32:47]
  ds_read_b64_tr_b16 a[248:249], v4 offset:1024
  ds_read_b64_tr_b16 a[250:251], v4 offset:1536
  v_cndmask_b32 v96, 0, v96, s[80:81]
  v_cndmask_b32 v97, 0, v97, s[80:81]
  v_cndmask_b32 v98, 0, v98, s[80:81]
  v_cndmask_b32 v99, 0, v99, s[80:81]
  v_cvt_pk_bf16_f32 v100, v96, v97
  v_cvt_pk_bf16_f32 v101, v98, v99
  buffer_store_dwordx2 v[100:101], v136, s[12:15], s76 offen sc1
  v_accvgpr_read_b32 v128, a172
  v_cvt_pk_bf16_f32 v129, v128, v128
  v_and_b32 v129, 0xffff0000, v129
  v_sub_f32 v128, v128, v129
  v_cvt_pk_bf16_f32 v128, v129, v128
  v_mfma_f32_32x32x16_bf16 v[48:63], a[228:231], v[240:243], v[48:63]
  ds_read_b64_tr_b16 a[252:253], v5 offset:1024
  ds_read_b64_tr_b16 a[254:255], v5 offset:1536
  ds_write_b32 v131, v128 offset:19456
  v_lshlrev_b32 v130, 3, v22
  s_waitcnt lgkmcnt(9)
  v_mfma_f32_32x32x16_bf16 v[32:47], a[232:235], v[244:247], v[32:47]
  s_waitcnt vmcnt(28)
  s_waitcnt lgkmcnt(0)
  s_barrier
  ds_read_b64_tr_b16 a[224:225], v2 offset:0
  ds_read_b64_tr_b16 a[226:227], v2 offset:512
  ds_read_b128 v[132:135], v130 offset:19968
  ds_read_b128 v[128:131], v130 offset:19456
  v_mfma_f32_32x32x16_bf16 v[48:63], a[236:239], v[244:247], v[48:63]
  ds_read_b64_tr_b16 a[228:229], v3 offset:0
  s_add_u32 m0, s65, 12288
  ds_read_b64_tr_b16 a[230:231], v3 offset:512
  buffer_load_dwordx4 v11, s[8:11], s55 offen offset:1024 lds
  s_waitcnt lgkmcnt(11)
  v_mfma_f32_32x32x16_bf16 v[32:47], a[240:243], v[248:251], v[32:47]
  ds_read_b64_tr_b16 a[232:233], v4 offset:0
  ds_read_b64_tr_b16 a[234:235], v4 offset:512
  v_mfma_f32_32x32x16_bf16 v[48:63], a[244:247], v[248:251], v[48:63]
  ds_read_b64_tr_b16 a[236:237], v5 offset:0
  s_add_u32 m0, s65, 12288
  ds_read_b64_tr_b16 a[238:239], v5 offset:512
  buffer_load_dwordx4 v10, s[8:11], s56 offen lds
  v_cmp_gt_u32 vcc, 32, v1
  s_waitcnt lgkmcnt(6)
  s_nop 0
  v_cndmask_b32 v128, v12, v128, vcc
  v_cndmask_b32 v132, v13, v132, vcc
  s_waitcnt lgkmcnt(11)
  v_mfma_f32_32x32x16_bf16 v[32:47], a[248:251], v[252:255], v[32:47]
  ds_read_b64_tr_b16 a[240:241], v2 offset:3072
  ds_read_b64_tr_b16 a[242:243], v2 offset:3584
  v_mfma_f32_32x32x16_bf16 v[32:47], v[128:131], v[16:19], v[32:47]
  v_mfma_f32_32x32x16_bf16 v[48:63], a[252:255], v[252:255], v[48:63]
  ds_read_b64_tr_b16 a[244:245], v3 offset:3072
  ds_read_b64_tr_b16 a[246:247], v3 offset:3584
  v_mfma_f32_32x32x16_bf16 v[48:63], v[132:135], v[16:19], v[48:63]
  s_waitcnt vmcnt(33)
  v_mov_b32 v12, v14
  v_mov_b32 v13, v15
  s_waitcnt vmcnt(2)
  s_lshr_b32 s75, s66, 2
  s_lshl_b32 s75, s75, 7
  s_and_b32 s76, s66, 3
  s_lshl_b32 s76, s76, 2
  s_add_u32 s76, s76, s64
  s_lshl_b32 s76, s76, 2
  s_add_u32 s75, s75, s76
  s_add_u32 s75, s75, 10305536
  v_mov_b32 v30, 1
  buffer_store_dword v30, off, s[12:15], s75 sc1
  s_mov_b32 s85, s86
  s_add_u32 s86, s86, 2
  s_add_u32 s84, s84, 1
L_ILOOP:
  s_add_u32 s77, s86, 2
  s_mov_b64 s[42:43], s[38:39]
  s_cmp_lt_u32 s77, 28
  s_cselect_b32 s44, 1605632, 0
  s_cselect_b32 s47, 3584, 0
  s_lshl_b32 s45, s77, 7
  s_mov_b32 s48, s45
  s_movk_i32 s46, 3584
  s_mov_b32 s49, 229376
  s_lshl_b32 s74, s66, 2
  s_add_u32 s74, s74, s64
  s_mul_i32 s74, s74, 114688
  s_lshl_b32 s75, s85, 12
  s_add_u32 s74, s74, s75
  v_mul_f32_e64 v64, v32, |v32|
  v_mul_f32_e64 v65, v33, |v33|
  v_mul_f32_e64 v66, v34, |v34|
  v_mul_f32_e64 v67, v35, |v35|
  v_mul_f32_e64 v68, v36, |v36|
  v_mul_f32_e64 v69, v37, |v37|
  v_mul_f32_e64 v70, v38, |v38|
  v_mul_f32_e64 v71, v39, |v39|
  v_mul_f32_e64 v72, v40, |v40|
  v_mul_f32_e64 v73, v41, |v41|
  v_mul_f32_e64 v74, v42, |v42|
  v_mul_f32_e64 v75, v43, |v43|
  v_mul_f32_e64 v76, v44, |v44|
  v_mul_f32_e64 v77, v45, |v45|
  v_mul_f32_e64 v78, v46, |v46|
  v_mul_f32_e64 v79, v47, |v47|
  s_waitcnt lgkmcnt(8)
  v_mfma_f32_32x32x16_bf16 v[32:47], a[224:227], v[144:147], 0
  ds_read_b64_tr_b16 a[248:249], v4 offset:3072
  ds_read_b64_tr_b16 a[250:251], v4 offset:3584
  v_mul_f32_e64 v80, v48, |v48|
  v_mul_f32_e64 v81, v49, |v49|
  v_mul_f32_e64 v82, v50, |v50|
  v_mul_f32_e64 v83, v51, |v51|
  v_mul_f32_e64 v84, v52, |v52|
  v_mul_f32_e64 v85, v53, |v53|
  v_mul_f32_e64 v86, v54, |v54|
  v_mul_f32_e64 v87, v55, |v55|
  v_mul_f32_e64 v88, v56, |v56|
  v_mul_f32_e64 v89, v57, |v57|
  v_mul_f32_e64 v90, v58, |v58|
  v_mul_f32_e64 v91, v59, |v59|
  v_mul_f32_e64 v92, v60, |v60|
  v_mul_f32_e64 v93, v61, |v61|
  v_mul_f32_e64 v94, v62, |v62|
  v_mul_f32_e64 v95, v63, |v63|
  v_cvt_pk_bf16_f32 v64, v64, v65
  v_cvt_pk_bf16_f32 v65, v66, v67
  v_pk_max_i16 v64, v64, 0
  v_pk_max_i16 v65, v65, 0
  ds_read_b64_tr_b16 a[164:165], v27 offset:0
  ds_read_b64_tr_b16 a[166:167], v28 offset:0
  v_mfma_f32_32x32x16_bf16 v[48:63], a[228:231], v[144:147], 0
  ds_read_b64_tr_b16 a[252:253], v5 offset:3072
  ds_read_b64_tr_b16 a[254:255], v5 offset:3584
  v_cvt_pk_bf16_f32 v66, v68, v69
  v_cvt_pk_bf16_f32 v67, v70, v71
  v_pk_max_i16 v66, v66, 0
  v_pk_max_i16 v67, v67, 0
  ds_read_b64_tr_b16 a[168:169], v27 offset:3072
  ds_read_b64_tr_b16 a[170:171], v28 offset:3072
  s_waitcnt lgkmcnt(12)
  v_mfma_f32_32x32x16_bf16 v[32:47], a[232:235], v[148:151], v[32:47]
  s_waitcnt vmcnt(10)
  s_barrier
  ds_read_b64_tr_b16 a[224:225], v2 offset:2048
  ds_read_b64_tr_b16 a[226:227], v2 offset:2560
  buffer_store_dwordx4 v[64:67], v8, s[12:15], s74 offen offset:0 sc1
  v_cvt_pk_bf16_f32 v68, v72, v73
  v_cvt_pk_bf16_f32 v69, v74, v75
  v_mfma_f32_32x32x16_bf16 v[48:63], a[236:239], v[148:151], v[48:63]
  ds_read_b64_tr_b16 a[228:229], v3 offset:2048
  s_add_u32 m0, s65, 0
  ds_read_b64_tr_b16 a[230:231], v3 offset:2560
  buffer_load_dwordx4 v11, s[8:11], s56 offen offset:1024 lds
  s_mov_b64 s[8:9], s[42:43]
  s_mov_b32 s10, s44
  s_mul_i32 s50, s57, s49
  v_mad_u32_u24 v10, v20, s46, v21
  v_add_u32 v10, s45, v10
  v_pk_max_i16 v68, v68, 0
  v_pk_max_i16 v69, v69, 0
  v_cvt_pk_bf16_f32 v70, v76, v77
  v_cvt_pk_bf16_f32 v71, v78, v79
  s_waitcnt lgkmcnt(8)
  v_mfma_f32_16x16x32_bf16 a[172:175], a[160:163], a[164:167], 0
  s_waitcnt lgkmcnt(12)
  v_mfma_f32_32x32x16_bf16 v[32:47], a[240:243], v[152:155], v[32:47]
  ds_read_b64_tr_b16 a[232:233], v4 offset:2048
  ds_read_b64_tr_b16 a[234:235], v4 offset:2560
  v_pk_max_i16 v70, v70, 0
  v_pk_max_i16 v71, v71, 0
  buffer_store_dwordx4 v[68:71], v8, s[12:15], s74 offen offset:1024 sc1
  s_waitcnt lgkmcnt(6)
  v_mfma_f32_16x16x32_bf16 a[172:175], a[160:163], a[168:171], a[172:175]
  v_mfma_f32_32x32x16_bf16 v[48:63], a[244:247], v[152:155], v[48:63]
  ds_read_b64_tr_b16 a[236:237], v5 offset:2048
  s_add_u32 m0, s65, 0
  ds_read_b64_tr_b16 a[238:239], v5 offset:2560
  buffer_load_dwordx4 v10, s[8:11], s50 offen lds
  s_lshr_b32 s77, s49, 1
  s_sub_u32 s77, s77, 1024
  v_add_u32 v11, s77, v10
  s_mul_i32 s51, s58, s49
  v_cvt_pk_bf16_f32 v72, v80, v81
  v_cvt_pk_bf16_f32 v73, v82, v83
  v_pk_max_i16 v72, v72, 0
  v_pk_max_i16 v73, v73, 0
  ds_read_b64_tr_b16 a[164:165], v27 offset:2048
  ds_read_b64_tr_b16 a[166:167], v28 offset:2048
  s_waitcnt lgkmcnt(12)
  v_mfma_f32_32x32x16_bf16 v[32:47], a[248:251], v[156:159], v[32:47]
  ds_read_b64_tr_b16 a[240:241], v2 offset:5120
  ds_read_b64_tr_b16 a[242:243], v2 offset:5632
  v_cvt_pk_bf16_f32 v74, v84, v85
  v_cvt_pk_bf16_f32 v75, v86, v87
  v_pk_max_i16 v74, v74, 0
  v_pk_max_i16 v75, v75, 0
  ds_read_b64_tr_b16 a[168:169], v27 offset:5120
  ds_read_b64_tr_b16 a[170:171], v28 offset:5120
  v_mfma_f32_32x32x16_bf16 v[48:63], a[252:255], v[156:159], v[48:63]
  ds_read_b64_tr_b16 a[244:245], v3 offset:5120
  ds_read_b64_tr_b16 a[246:247], v3 offset:5632
  s_mov_b32 s18, s47
  buffer_load_ushort v14, v22, s[16:19], s48 offen
  buffer_load_ushort v15, v22, s[16:19], s48 offen offset:64
  buffer_store_dwordx4 v[72:75], v8, s[12:15], s74 offen offset:2048 sc1
  v_cvt_pk_bf16_f32 v76, v88, v89
  v_cvt_pk_bf16_f32 v77, v90, v91
  s_waitcnt lgkmcnt(12)
  v_mfma_f32_32x32x16_bf16 v[32:47], a[224:227], v[160:163], v[32:47]
  ds_read_b64_tr_b16 a[248:249], v4 offset:5120
  ds_read_b64_tr_b16 a[250:251], v4 offset:5632
  v_pk_max_i16 v76, v76, 0
  v_pk_max_i16 v77, v77, 0
  v_cvt_pk_bf16_f32 v78, v92, v93
  v_cvt_pk_bf16_f32 v79, v94, v95
  s_waitcnt lgkmcnt(8)
  v_mfma_f32_16x16x32_bf16 a[172:175], a[160:163], a[164:167], a[172:175]
  v_mfma_f32_32x32x16_bf16 v[48:63], a[228:231], v[160:163], v[48:63]
  ds_read_b64_tr_b16 a[252:253], v5 offset:5120
  ds_read_b64_tr_b16 a[254:255], v5 offset:5632
  v_pk_max_i16 v78, v78, 0
  v_pk_max_i16 v79, v79, 0
  buffer_store_dwordx4 v[76:79], v8, s[12:15], s74 offen offset:3072 sc1
  s_waitcnt lgkmcnt(6)
  v_mfma_f32_16x16x32_bf16 a[172:175], a[160:163], a[168:171], a[172:175]
  s_waitcnt lgkmcnt(12)
  v_mfma_f32_32x32x16_bf16 v[32:47], a[232:235], v[164:167], v[32:47]
  s_waitcnt vmcnt(15)
  s_barrier
  ds_read_b64_tr_b16 a[224:225], v2 offset:4096
  ds_read_b64_tr_b16 a[226:227], v2 offset:4608
  ds_read_b64_tr_b16 a[164:165], v27 offset:4096
  ds_read_b64_tr_b16 a[166:167], v28 offset:4096
  v_mfma_f32_32x32x16_bf16 v[48:63], a[236:239], v[164:167], v[48:63]
  ds_read_b64_tr_b16 a[228:229], v3 offset:4096
  s_add_u32 m0, s65, 2048
  ds_read_b64_tr_b16 a[230:231], v3 offset:4608
  buffer_load_dwordx4 v11, s[8:11], s50 offen offset:1024 lds
  ds_read_b64_tr_b16 a[168:169], v27 offset:7168
  ds_read_b64_tr_b16 a[170:171], v28 offset:7168
  s_waitcnt lgkmcnt(12)
  v_mfma_f32_32x32x16_bf16 v[32:47], a[240:243], v[168:171], v[32:47]
  ds_read_b64_tr_b16 a[232:233], v4 offset:4096
  ds_read_b64_tr_b16 a[234:235], v4 offset:4608
  v_mfma_f32_32x32x16_bf16 v[48:63], a[244:247], v[168:171], v[48:63]
  ds_read_b64_tr_b16 a[236:237], v5 offset:4096
  s_add_u32 m0, s65, 2048
  ds_read_b64_tr_b16 a[238:239], v5 offset:4608
  buffer_load_dwordx4 v10, s[8:11], s51 offen lds
  s_mul_i32 s52, s59, s49
  s_waitcnt lgkmcnt(8)
  v_mfma_f32_16x16x32_bf16 a[172:175], a[160:163], a[164:167], a[172:175]
  s_waitcnt lgkmcnt(12)
  v_mfma_f32_32x32x16_bf16 v[32:47], a[248:251], v[172:175], v[32:47]
  ds_read_b64_tr_b16 a[240:241], v2 offset:7168
  ds_read_b64_tr_b16 a[242:243], v2 offset:7680
  s_waitcnt lgkmcnt(6)
  v_mfma_f32_16x16x32_bf16 a[172:175], a[160:163], a[168:171], a[172:175]
  v_mfma_f32_32x32x16_bf16 v[48:63], a[252:255], v[172:175], v[48:63]
  ds_read_b64_tr_b16 a[244:245], v3 offset:7168
  ds_read_b64_tr_b16 a[246:247], v3 offset:7680
  s_waitcnt lgkmcnt(10)
  v_mfma_f32_32x32x16_bf16 v[32:47], a[224:227], v[176:179], v[32:47]
  ds_read_b64_tr_b16 a[248:249], v4 offset:7168
  ds_read_b64_tr_b16 a[250:251], v4 offset:7680
  v_mfma_f32_32x32x16_bf16 v[48:63], a[228:231], v[176:179], v[48:63]
  ds_read_b64_tr_b16 a[252:253], v5 offset:7168
  ds_read_b64_tr_b16 a[254:255], v5 offset:7680
  s_waitcnt lgkmcnt(8)
  v_mfma_f32_32x32x16_bf16 v[32:47], a[232:235], v[180:183], v[32:47]
  s_waitcnt vmcnt(15)
  s_barrier
  ds_read_b64_tr_b16 a[224:225], v2 offset:6144
  ds_read_b64_tr_b16 a[226:227], v2 offset:6656
  ds_read_b64_tr_b16 a[164:165], v27 offset:6144
  ds_read_b64_tr_b16 a[166:167], v28 offset:6144
  v_mfma_f32_32x32x16_bf16 v[48:63], a[236:239], v[180:183], v[48:63]
  ds_read_b64_tr_b16 a[228:229], v3 offset:6144
  s_add_u32 m0, s65, 4096
  ds_read_b64_tr_b16 a[230:231], v3 offset:6656
  buffer_load_dwordx4 v11, s[8:11], s51 offen offset:1024 lds
  s_waitcnt vmcnt(3)
  v_mov_b32 v30, s84
  buffer_store_dword v30, off, s[12:15], s0 sc1
  ds_read_b64_tr_b16 a[168:169], v27 offset:9216
  ds_read_b64_tr_b16 a[170:171], v28 offset:9216
  s_waitcnt lgkmcnt(12)
  v_mfma_f32_32x32x16_bf16 v[32:47], a[240:243], v[184:187], v[32:47]
  ds_read_b64_tr_b16 a[232:233], v4 offset:6144
  ds_read_b64_tr_b16 a[234:235], v4 offset:6656
  v_mfma_f32_32x32x16_bf16 v[48:63], a[244:247], v[184:187], v[48:63]
  ds_read_b64_tr_b16 a[236:237], v5 offset:6144
  s_add_u32 m0, s65, 4096
  ds_read_b64_tr_b16 a[238:239], v5 offset:6656
  buffer_load_dwordx4 v10, s[8:11], s52 offen lds
  s_mul_i32 s53, s60, s49
  s_waitcnt lgkmcnt(8)
  v_mfma_f32_16x16x32_bf16 a[172:175], a[160:163], a[164:167], a[172:175]
  s_waitcnt lgkmcnt(12)
  v_mfma_f32_32x32x16_bf16 v[32:47], a[248:251], v[188:191], v[32:47]
  ds_read_b64_tr_b16 a[240:241], v2 offset:9216
  ds_read_b64_tr_b16 a[242:243], v2 offset:9728
  s_waitcnt lgkmcnt(6)
  v_mfma_f32_16x16x32_bf16 a[172:175], a[160:163], a[168:171], a[172:175]
  v_mfma_f32_32x32x16_bf16 v[48:63], a[252:255], v[188:191], v[48:63]
  ds_read_b64_tr_b16 a[244:245], v3 offset:9216
  ds_read_b64_tr_b16 a[246:247], v3 offset:9728
  s_waitcnt lgkmcnt(10)
  v_mfma_f32_32x32x16_bf16 v[32:47], a[224:227], v[192:195], v[32:47]
  ds_read_b64_tr_b16 a[248:249], v4 offset:9216
  ds_read_b64_tr_b16 a[250:251], v4 offset:9728
  v_mfma_f32_32x32x16_bf16 v[48:63], a[228:231], v[192:195], v[48:63]
  ds_read_b64_tr_b16 a[252:253], v5 offset:9216
  ds_read_b64_tr_b16 a[254:255], v5 offset:9728
  s_waitcnt lgkmcnt(8)
  v_mfma_f32_32x32x16_bf16 v[32:47], a[232:235], v[196:199], v[32:47]
  s_waitcnt vmcnt(16)
  s_barrier
  ds_read_b64_tr_b16 a[224:225], v2 offset:8192
  ds_read_b64_tr_b16 a[226:227], v2 offset:8704
  ds_read_b64_tr_b16 a[164:165], v27 offset:8192
  ds_read_b64_tr_b16 a[166:167], v28 offset:8192
  v_mfma_f32_32x32x16_bf16 v[48:63], a[236:239], v[196:199], v[48:63]
  ds_read_b64_tr_b16 a[228:229], v3 offset:8192
  s_add_u32 m0, s65, 6144
  ds_read_b64_tr_b16 a[230:231], v3 offset:8704
  buffer_load_dwordx4 v11, s[8:11], s52 offen offset:1024 lds
  ds_read_b64_tr_b16 a[168:169], v27 offset:11264
  ds_read_b64_tr_b16 a[170:171], v28 offset:11264
  s_waitcnt lgkmcnt(12)
  v_mfma_f32_32x32x16_bf16 v[32:47], a[240:243], v[200:203], v[32:47]
  ds_read_b64_tr_b16 a[232:233], v4 offset:8192
  ds_read_b64_tr_b16 a[234:235], v4 offset:8704
  v_mfma_f32_32x32x16_bf16 v[48:63], a[244:247], v[200:203], v[48:63]
  ds_read_b64_tr_b16 a[236:237], v5 offset:8192
  s_add_u32 m0, s65, 6144
  ds_read_b64_tr_b16 a[238:239], v5 offset:8704
  buffer_load_dwordx4 v10, s[8:11], s53 offen lds
  s_mul_i32 s54, s61, s49
  s_waitcnt lgkmcnt(8)
  v_mfma_f32_16x16x32_bf16 a[172:175], a[160:163], a[164:167], a[172:175]
  s_waitcnt lgkmcnt(12)
  v_mfma_f32_32x32x16_bf16 v[32:47], a[248:251], v[204:207], v[32:47]
  ds_read_b64_tr_b16 a[240:241], v2 offset:11264
  ds_read_b64_tr_b16 a[242:243], v2 offset:11776
  s_waitcnt lgkmcnt(6)
  v_mfma_f32_16x16x32_bf16 a[172:175], a[160:163], a[168:171], a[172:175]
  v_mfma_f32_32x32x16_bf16 v[48:63], a[252:255], v[204:207], v[48:63]
  ds_read_b64_tr_b16 a[244:245], v3 offset:11264
  ds_read_b64_tr_b16 a[246:247], v3 offset:11776
  s_waitcnt lgkmcnt(10)
  v_mfma_f32_32x32x16_bf16 v[32:47], a[224:227], v[208:211], v[32:47]
  ds_read_b64_tr_b16 a[248:249], v4 offset:11264
  ds_read_b64_tr_b16 a[250:251], v4 offset:11776
  v_mfma_f32_32x32x16_bf16 v[48:63], a[228:231], v[208:211], v[48:63]
  ds_read_b64_tr_b16 a[252:253], v5 offset:11264
  ds_read_b64_tr_b16 a[254:255], v5 offset:11776
  s_waitcnt lgkmcnt(8)
  v_mfma_f32_32x32x16_bf16 v[32:47], a[232:235], v[212:215], v[32:47]
  s_waitcnt vmcnt(16)
  s_barrier
  ds_read_b64_tr_b16 a[224:225], v2 offset:10240
  ds_read_b64_tr_b16 a[226:227], v2 offset:10752
  ds_read_b64_tr_b16 a[164:165], v27 offset:10240
  ds_read_b64_tr_b16 a[166:167], v28 offset:10240
  v_mfma_f32_32x32x16_bf16 v[48:63], a[236:239], v[212:215], v[48:63]
  ds_read_b64_tr_b16 a[228:229], v3 offset:10240
  s_add_u32 m0, s65, 8192
  ds_read_b64_tr_b16 a[230:231], v3 offset:10752
  buffer_load_dwordx4 v11, s[8:11], s53 offen offset:1024 lds
  ds_read_b64_tr_b16 a[168:169], v27 offset:13312
  ds_read_b64_tr_b16 a[170:171], v28 offset:13312
  s_waitcnt lgkmcnt(12)
  v_mfma_f32_32x32x16_bf16 v[32:47], a[240:243], v[216:219], v[32:47]
  ds_read_b64_tr_b16 a[232:233], v4 offset:10240
  ds_read_b64_tr_b16 a[234:235], v4 offset:10752
  v_mfma_f32_32x32x16_bf16 v[48:63], a[244:247], v[216:219], v[48:63]
  ds_read_b64_tr_b16 a[236:237], v5 offset:10240
  s_add_u32 m0, s65, 8192
  ds_read_b64_tr_b16 a[238:239], v5 offset:10752
  buffer_load_dwordx4 v10, s[8:11], s54 offen lds
  s_mul_i32 s55, s62, s49
  s_waitcnt lgkmcnt(8)
  v_mfma_f32_16x16x32_bf16 a[172:175], a[160:163], a[164:167], a[172:175]
  s_waitcnt lgkmcnt(12)
  v_mfma_f32_32x32x16_bf16 v[32:47], a[248:251], v[220:223], v[32:47]
  ds_read_b64_tr_b16 a[240:241], v2 offset:13312
  ds_read_b64_tr_b16 a[242:243], v2 offset:13824
  s_waitcnt lgkmcnt(6)
  v_mfma_f32_16x16x32_bf16 a[172:175], a[160:163], a[168:171], a[172:175]
  v_mfma_f32_32x32x16_bf16 v[48:63], a[252:255], v[220:223], v[48:63]
  ds_read_b64_tr_b16 a[244:245], v3 offset:13312
  ds_read_b64_tr_b16 a[246:247], v3 offset:13824
  s_waitcnt lgkmcnt(10)
  v_mfma_f32_32x32x16_bf16 v[32:47], a[224:227], v[224:227], v[32:47]
  ds_read_b64_tr_b16 a[248:249], v4 offset:13312
  ds_read_b64_tr_b16 a[250:251], v4 offset:13824
  v_mfma_f32_32x32x16_bf16 v[48:63], a[228:231], v[224:227], v[48:63]
  ds_read_b64_tr_b16 a[252:253], v5 offset:13312
  ds_read_b64_tr_b16 a[254:255], v5 offset:13824
  s_waitcnt lgkmcnt(8)
  v_mfma_f32_32x32x16_bf16 v[32:47], a[232:235], v[228:231], v[32:47]
  s_waitcnt vmcnt(15)
  s_barrier
  ds_read_b64_tr_b16 a[224:225], v2 offset:12288
  ds_read_b64_tr_b16 a[226:227], v2 offset:12800
  ds_read_b64_tr_b16 a[164:165], v27 offset:12288
  ds_read_b64_tr_b16 a[166:167], v28 offset:12288
  v_mfma_f32_32x32x16_bf16 v[48:63], a[236:239], v[228:231], v[48:63]
  ds_read_b64_tr_b16 a[228:229], v3 offset:12288
  s_add_u32 m0, s65, 10240
  ds_read_b64_tr_b16 a[230:231], v3 offset:12800
  buffer_load_dwordx4 v11, s[8:11], s54 offen offset:1024 lds
  ds_read_b64_tr_b16 a[168:169], v27 offset:1024
  ds_read_b64_tr_b16 a[170:171], v28 offset:1024
  s_waitcnt lgkmcnt(12)
  v_mfma_f32_32x32x16_bf16 v[32:47], a[240:243], v[232:235], v[32:47]
  ds_read_b64_tr_b16 a[232:233], v4 offset:12288
  ds_read_b64_tr_b16 a[234:235], v4 offset:12800
  v_mfma_f32_32x32x16_bf16 v[48:63], a[244:247], v[232:235], v[48:63]
  ds_read_b64_tr_b16 a[236:237], v5 offset:12288
  s_add_u32 m0, s65, 10240
  ds_read_b64_tr_b16 a[238:239], v5 offset:12800
  buffer_load_dwordx4 v10, s[8:11], s55 offen lds
  s_mul_i32 s56, s63, s49
  s_waitcnt lgkmcnt(8)
  v_mfma_f32_16x16x32_bf16 a[172:175], a[160:163], a[164:167], a[172:175]
  s_waitcnt lgkmcnt(12)
  v_mfma_f32_32x32x16_bf16 v[32:47], a[248:251], v[236:239], v[32:47]
  ds_read_b64_tr_b16 a[240:241], v2 offset:1024
  ds_read_b64_tr_b16 a[242:243], v2 offset:1536
  s_waitcnt lgkmcnt(6)
  v_mfma_f32_16x16x32_bf16 a[172:175], a[160:163], a[168:171], a[172:175]
  v_mfma_f32_32x32x16_bf16 v[48:63], a[252:255], v[236:239], v[48:63]
  ds_read_b64_tr_b16 a[244:245], v3 offset:1024
  ds_read_b64_tr_b16 a[246:247], v3 offset:1536
  v_lshl_add_u32 v131, s64, 2, v8
  s_waitcnt lgkmcnt(10)
  v_mfma_f32_32x32x16_bf16 v[32:47], a[224:227], v[240:243], v[32:47]
  ds_read_b64_tr_b16 a[248:249], v4 offset:1024
  ds_read_b64_tr_b16 a[250:251], v4 offset:1536
  v_accvgpr_read_b32 v128, a172
  v_cvt_pk_bf16_f32 v129, v128, v128
  v_and_b32 v129, 0xffff0000, v129
  v_sub_f32 v128, v128, v129
  v_cvt_pk_bf16_f32 v128, v129, v128
  v_mfma_f32_32x32x16_bf16 v[48:63], a[228:231], v[240:243], v[48:63]
  ds_read_b64_tr_b16 a[252:253], v5 offset:1024
  ds_read_b64_tr_b16 a[254:255], v5 offset:1536
  ds_write_b32 v131, v128 offset:19456
  v_lshlrev_b32 v130, 3, v22
  s_waitcnt lgkmcnt(9)
  v_mfma_f32_32x32x16_bf16 v[32:47], a[232:235], v[244:247], v[32:47]
  s_waitcnt vmcnt(10)
  s_waitcnt lgkmcnt(0)
  s_barrier
  ds_read_b64_tr_b16 a[224:225], v2 offset:0
  ds_read_b64_tr_b16 a[226:227], v2 offset:512
  ds_read_b128 v[132:135], v130 offset:19968
  ds_read_b128 v[128:131], v130 offset:19456
  v_mfma_f32_32x32x16_bf16 v[48:63], a[236:239], v[244:247], v[48:63]
  ds_read_b64_tr_b16 a[228:229], v3 offset:0
  s_add_u32 m0, s65, 12288
  ds_read_b64_tr_b16 a[230:231], v3 offset:512
  buffer_load_dwordx4 v11, s[8:11], s55 offen offset:1024 lds
  s_waitcnt lgkmcnt(11)
  v_mfma_f32_32x32x16_bf16 v[32:47], a[240:243], v[248:251], v[32:47]
  ds_read_b64_tr_b16 a[232:233], v4 offset:0
  ds_read_b64_tr_b16 a[234:235], v4 offset:512
  v_mfma_f32_32x32x16_bf16 v[48:63], a[244:247], v[248:251], v[48:63]
  ds_read_b64_tr_b16 a[236:237], v5 offset:0
  s_add_u32 m0, s65, 12288
  ds_read_b64_tr_b16 a[238:239], v5 offset:512
  buffer_load_dwordx4 v10, s[8:11], s56 offen lds
  v_cmp_gt_u32 vcc, 32, v1
  s_waitcnt lgkmcnt(6)
  s_nop 0
  v_cndmask_b32 v128, v12, v128, vcc
  v_cndmask_b32 v132, v13, v132, vcc
  s_waitcnt lgkmcnt(11)
  v_mfma_f32_32x32x16_bf16 v[32:47], a[248:251], v[252:255], v[32:47]
  ds_read_b64_tr_b16 a[240:241], v2 offset:3072
  ds_read_b64_tr_b16 a[242:243], v2 offset:3584
  v_mfma_f32_32x32x16_bf16 v[32:47], v[128:131], v[16:19], v[32:47]
  v_mfma_f32_32x32x16_bf16 v[48:63], a[252:255], v[252:255], v[48:63]
  ds_read_b64_tr_b16 a[244:245], v3 offset:3072
  ds_read_b64_tr_b16 a[246:247], v3 offset:3584
  v_mfma_f32_32x32x16_bf16 v[48:63], v[132:135], v[16:19], v[48:63]
  s_waitcnt vmcnt(15)
  v_mov_b32 v12, v14
  v_mov_b32 v13, v15
  s_mov_b32 s85, s86
  s_add_u32 s86, s86, 2
  s_add_u32 s84, s84, 1
  s_cmp_lt_u32 s86, 28
  s_cbranch_scc1 L_ILOOP
  s_lshl_b32 s74, s66, 2
  s_add_u32 s74, s74, s64
  s_mul_i32 s74, s74, 114688
  s_lshl_b32 s75, s85, 12
  s_add_u32 s74, s74, s75
  s_nop 7
  v_mul_f32_e64 v64, v32, |v32|
  v_mul_f32_e64 v65, v33, |v33|
  v_mul_f32_e64 v66, v34, |v34|
  v_mul_f32_e64 v67, v35, |v35|
  v_mul_f32_e64 v68, v36, |v36|
  v_mul_f32_e64 v69, v37, |v37|
  v_mul_f32_e64 v70, v38, |v38|
  v_mul_f32_e64 v71, v39, |v39|
  v_mul_f32_e64 v72, v40, |v40|
  v_mul_f32_e64 v73, v41, |v41|
  v_mul_f32_e64 v74, v42, |v42|
  v_mul_f32_e64 v75, v43, |v43|
  v_mul_f32_e64 v76, v44, |v44|
  v_mul_f32_e64 v77, v45, |v45|
  v_mul_f32_e64 v78, v46, |v46|
  v_mul_f32_e64 v79, v47, |v47|
  v_mul_f32_e64 v80, v48, |v48|
  v_mul_f32_e64 v81, v49, |v49|
  v_mul_f32_e64 v82, v50, |v50|
  v_mul_f32_e64 v83, v51, |v51|
  v_mul_f32_e64 v84, v52, |v52|
  v_mul_f32_e64 v85, v53, |v53|
  v_mul_f32_e64 v86, v54, |v54|
  v_mul_f32_e64 v87, v55, |v55|
  v_mul_f32_e64 v88, v56, |v56|
  v_mul_f32_e64 v89, v57, |v57|
  v_mul_f32_e64 v90, v58, |v58|
  v_mul_f32_e64 v91, v59, |v59|
  v_mul_f32_e64 v92, v60, |v60|
  v_mul_f32_e64 v93, v61, |v61|
  v_mul_f32_e64 v94, v62, |v62|
  v_mul_f32_e64 v95, v63, |v63|
  v_cvt_pk_bf16_f32 v64, v64, v65
  v_cvt_pk_bf16_f32 v65, v66, v67
  v_pk_max_i16 v64, v64, 0
  v_pk_max_i16 v65, v65, 0
  v_cvt_pk_bf16_f32 v66, v68, v69
  v_cvt_pk_bf16_f32 v67, v70, v71
  v_pk_max_i16 v66, v66, 0
  v_pk_max_i16 v67, v67, 0
  buffer_store_dwordx4 v[64:67], v8, s[12:15], s74 offen offset:0 sc1
  v_cvt_pk_bf16_f32 v68, v72, v73
  v_cvt_pk_bf16_f32 v69, v74, v75
  v_pk_max_i16 v68, v68, 0
  v_pk_max_i16 v69, v69, 0
  v_cvt_pk_bf16_f32 v70, v76, v77
  v_cvt_pk_bf16_f32 v71, v78, v79
  v_pk_max_i16 v70, v70, 0
  v_pk_max_i16 v71, v71, 0
  buffer_store_dwordx4 v[68:71], v8, s[12:15], s74 offen offset:1024 sc1
  v_cvt_pk_bf16_f32 v72, v80, v81
  v_cvt_pk_bf16_f32 v73, v82, v83
  v_pk_max_i16 v72, v72, 0
  v_pk_max_i16 v73, v73, 0
  v_cvt_pk_bf16_f32 v74, v84, v85
  v_cvt_pk_bf16_f32 v75, v86, v87
  v_pk_max_i16 v74, v74, 0
  v_pk_max_i16 v75, v75, 0
  buffer_store_dwordx4 v[72:75], v8, s[12:15], s74 offen offset:2048 sc1
  v_cvt_pk_bf16_f32 v76, v88, v89
  v_cvt_pk_bf16_f32 v77, v90, v91
  v_pk_max_i16 v76, v76, 0
  v_pk_max_i16 v77, v77, 0
  v_cvt_pk_bf16_f32 v78, v92, v93
  v_cvt_pk_bf16_f32 v79, v94, v95
  v_pk_max_i16 v78, v78, 0
  v_pk_max_i16 v79, v79, 0
  buffer_store_dwordx4 v[76:79], v8, s[12:15], s74 offen offset:3072 sc1
  s_waitcnt vmcnt(0)
  v_mov_b32 v30, s84
  buffer_store_dword v30, off, s[12:15], s0 sc1
  s_endpgm
.section .rodata,"a"
.p2align 6
.amdhsa_kernel recurrent_scan__linear_attn_block__dense_activation_squared_relu__prompt_kernel
  .amdhsa_next_free_vgpr 512
  .amdhsa_next_free_sgpr 102
  .amdhsa_accum_offset 256
  .amdhsa_group_segment_fixed_size 0
  .amdhsa_kernarg_size 88
  .amdhsa_user_sgpr_count 2
  .amdhsa_user_sgpr_kernarg_segment_ptr 1
  .amdhsa_system_sgpr_workgroup_id_x 1
.end_amdhsa_kernel
```
